```python
import torch

def _softmax(x, axis=-1):
    return torch.softmax(x, dim=axis)
def _gelu(x):
    return torch.nn.functional.gelu(x, approximate="tanh")
def _silu(x):
    return torch.nn.functional.silu(x)
def _sigmoid(x):
    return torch.sigmoid(x)
def _layernorm(x, axis=-1, eps=1e-5):
    m = x.mean(dim=axis, keepdim=True)
    v = x.var(dim=axis, keepdim=True, unbiased=False)
    return (x - m) / torch.sqrt(v + eps)
def _scatter_add(tgt, idx, src, axis=0):
    return tgt.clone().index_add_(axis, idx, src)
def _segment_sum(src, seg, n):
    out = torch.zeros((n,) + src.shape[1:], dtype=src.dtype)
    return out.index_add_(0, seg, src)
def _pad(x, pw):
    flat = tuple(v for pair in reversed(pw) for v in pair)
    return torch.nn.functional.pad(x, flat)

kernel_name = 'gated_mix__ssm_conv_s4d__softmax_full_mha__prompt'

def setup_inputs():

    _w = (lambda a: (lambda t: t.to(torch.bfloat16) if t.is_floating_point() else t)(torch.as_tensor(a)))
    def _A_setup():
        Bsz, L, D, N = 1, 2048, 448, 256
        return {
            "u": _w((lambda *s: torch.randn(*s, dtype=torch.bfloat16) * 0.05)(Bsz, L, D)),
            "log_A_real": _w((lambda *s: torch.randn(*s, dtype=torch.bfloat16) * 3.2)(D, N) * 0.5),
            "A_imag": _w((lambda *s: torch.randn(*s, dtype=torch.bfloat16) * 0.05)(D, N) * 3.14),
            "C_real": _w((lambda *s: torch.randn(*s, dtype=torch.bfloat16) * 0.8)(D, N) / N ** 0.5),
            "C_imag": _w((lambda *s: torch.randn(*s, dtype=torch.bfloat16) * 0.8)(D, N) / N ** 0.5),
            "log_dt": _w((lambda *s: torch.randn(*s, dtype=torch.bfloat16) * 0.05)(D) * 0.5 - 4.0),
            "D_skip": _w((lambda *s: torch.randn(*s, dtype=torch.bfloat16) * 0.1)(D)),
        }
    _A_in = _A_setup()

    def _B_setup():
        B, S, D = 1, 2048, 448
        return {
            "x": _w((lambda *s: torch.randn(*s, dtype=torch.bfloat16) * 0.05)(B, S, D)),
            "wqkv": _w((lambda *s: torch.randn(*s, dtype=torch.bfloat16) * 0.8)(D, 3 * D)),
            "wo": _w((lambda *s: torch.randn(*s, dtype=torch.bfloat16) * 0.05)(D, D)),
        }
    _B_in = _B_setup()

    return {
        "A_u": _A_in["u"],
        "A_log_A_real": _A_in["log_A_real"],
        "A_A_imag": _A_in["A_imag"],
        "A_C_real": _A_in["C_real"],
        "A_C_imag": _A_in["C_imag"],
        "A_log_dt": _A_in["log_dt"],
        "A_D_skip": _A_in["D_skip"],
        "B_x": _B_in["x"],
        "B_wqkv": _B_in["wqkv"],
        "B_wo": _B_in["wo"],
        "gate_w": _w((lambda *s: torch.randn(*s, dtype=torch.bfloat16) * 0.05)(448) * 16.0),
    }

def reference(A_u, A_log_A_real, A_A_imag, A_C_real, A_C_imag, A_log_dt, A_D_skip, B_x, B_wqkv, B_wo, gate_w):
    def _A_ref(u, log_A_real, A_imag, C_real, C_imag, log_dt, D_skip):
        L = u.shape[1]
        dt = torch.exp(log_dt)
        A = -torch.exp(log_A_real) + 1j * A_imag
        C = (C_real + 1j * C_imag) * dt[:, None]
        pos = (lambda x, dt: x.to(dt))(torch.arange(L), log_dt.dtype)
        P = torch.exp((A * dt[:, None])[:, :, None] * pos[None, None, :])
        K = 2.0 * torch.einsum("dn,dnl->dl", C, P).real
        L2 = 2 * L
        u_t = (lambda x, *d: x.permute(*d))(u, 0, 2, 1)
        Kf = (lambda x, *a, **k: torch.fft.rfft(x.float(), *a, **k))(K, L2)
        Uf = (lambda x, *a, **k: torch.fft.rfft(x.float(), *a, **k))(u_t, L2)
        y = (lambda x, *a, **k: torch.fft.irfft(x, *a, **k).to(torch.bfloat16))(Uf * Kf[None, :, :], L2)[:, :, :L]
        y = (lambda x, *d: x.permute(*d))(y, 0, 2, 1)
        return y + u * D_skip[None, None, :]

    def _B_ref(x, wqkv, wo):
        B, S, D = x.shape
        H = 16; Dh = D // H
        qkv = (lambda x, *d: x.permute(*d))((x @ wqkv).reshape(B, S, 3, H, Dh), 2, 0, 3, 1, 4)
        q, k, v = qkv[0], qkv[1], qkv[2]
        scale = Dh ** -0.5
        scores = torch.einsum("bhqd,bhkd->bhqk", q, k) * scale
        p = _softmax(scores, axis=-1)
        o = torch.einsum("bhqk,bhkd->bhqd", p, v)
        return (lambda x, *d: x.permute(*d))(o, 0, 2, 1, 3).reshape(B, S, D) @ wo

    x = A_u
    g = _sigmoid((x * gate_w).sum(-1, keepdims=True))
    a = _A_ref(x, A_log_A_real, A_A_imag, A_C_real, A_C_imag, A_log_dt, A_D_skip)
    b = _B_ref(x, B_wqkv, B_wo)
    return g * a + (1 - g) * b
```

```asm
; @launch kernel=gm_ka_kernel grid=(512,1,1) block=(256,1,1) lds=81920
; @launch kernel=gm_kb_kernel grid=(480,1,1) block=(256,1,1) lds=81920
; @launch kernel=gm_kc_kernel grid=(224,1,1) block=(256,1,1) lds=131072
.amdgcn_target "amdgcn-amd-amdhsa--gfx950"
.text
.globl gm_ka_kernel
.p2align 8
.type gm_ka_kernel,@function
gm_ka_kernel:
    s_cmp_lt_u32 s2, 224
    s_cbranch_scc1 R_1
    s_cmp_lt_u32 s2, 480
    s_cbranch_scc1 R_2
    s_cmp_lt_u32 s2, 512
    s_cbranch_scc1 R_3
    s_endpgm
R_1:
    s_load_dwordx2 s[4:5], s[0:1], 0
    s_load_dwordx2 s[8:9], s[0:1], 104
    s_load_dwordx2 s[12:13], s[0:1], 8
    s_load_dwordx2 s[16:17], s[0:1], 16
    s_load_dwordx2 s[20:21], s[0:1], 24
    s_load_dwordx2 s[24:25], s[0:1], 32
    s_load_dwordx2 s[28:29], s[0:1], 40
    s_and_b32 s52, s2, 3
    s_lshl_b32 s52, s52, 3
    s_and_b32 s53, s2, 4
    s_or_b32 s52, s52, s53
    s_bfe_u32 s53, s2, 0x20003
    s_or_b32 s52, s52, s53
    s_lshr_b32 s53, s2, 5
    s_and_b32 s3, s2, 7
    s_mul_i32 s3, s3, 28
    s_lshr_b32 s2, s2, 3
    s_add_u32 s32, s3, s2
    s_lshl_b32 s33, s32, 2
    v_lshrrev_b32 v2, 6, v0
    v_and_b32 v1, 63, v0
    v_readfirstlane_b32 s34, v2
    s_waitcnt lgkmcnt(0)
    s_mov_b32 s6, 0x1c0000
    s_mov_b32 s7, 0x20000
    s_mov_b32 s10, 0x1000000
    s_mov_b32 s11, 0x20000
    s_mov_b32 s14, 0x38000
    s_mov_b32 s15, 0x20000
    s_mov_b32 s18, 0x38000
    s_mov_b32 s19, 0x20000
    s_mov_b32 s22, 0x38000
    s_mov_b32 s23, 0x20000
    s_mov_b32 s26, 0x38000
    s_mov_b32 s27, 0x20000
    s_load_dword s35, s[28:29], s33
    v_lshlrev_b32 v2, 1, v0
    s_lshl_b32 s3, s32, 10
    buffer_load_ushort v8, v2, s[12:15], s3 offen offset:0
    buffer_load_ushort v9, v2, s[16:19], s3 offen offset:0
    buffer_load_ushort v10, v2, s[20:23], s3 offen offset:0
    buffer_load_ushort v11, v2, s[24:27], s3 offen offset:0
    buffer_load_ushort v12, v2, s[12:15], s3 offen offset:512
    buffer_load_ushort v13, v2, s[16:19], s3 offen offset:512
    buffer_load_ushort v14, v2, s[20:23], s3 offen offset:512
    buffer_load_ushort v15, v2, s[24:27], s3 offen offset:512
    v_lshrrev_b32 v5, 3, v1
    v_mul_u32_u24 v5, 896, v5
    v_and_b32 v6, 7, v1
    v_lshl_add_u32 v16, v6, 4, v5
    s_lshl_b32 s3, s52, 2
    s_add_u32 s3, s3, s34
    s_mul_i32 s3, s3, 14336
    s_lshl_b32 s44, s53, 7
    s_add_u32 s3, s3, s44
    s_lshl_b32 s44, s34, 11
    s_add_u32 m0, s44, 67072
    s_nop 0
    buffer_load_dwordx4 v16, s[4:7], s3 offen lds
    s_add_u32 s3, s3, 7168
    s_add_u32 m0, s44, 68096
    s_nop 0
    buffer_load_dwordx4 v16, s[4:7], s3 offen lds
    s_mov_b32 s40, 0x3fb8aa3b
    s_mov_b32 s41, 0x32a57060
    s_mov_b32 s42, 0x3f317218
    s_mov_b32 s43, 0x3e22f983
    v_lshlrev_b32 v4, 4, v0
    s_mul_i32 s45, s34, 14416
    v_lshl_add_u32 v28, v1, 2, s45
    v_and_b32 v5, 31, v1
    v_lshrrev_b32 v6, 5, v1
    v_mul_u32_u24 v30, 272, v5
    v_lshl_add_u32 v30, v6, 4, v30
    v_add_u32 v30, s45, v30
    v_add_u32 v29, 8704, v30
    v_lshl_add_u32 v2, v1, 4, s45
    s_lshl_b32 s46, s34, 10
    v_lshl_add_u32 v3, v1, 4, s46
    s_lshr_b32 s44, s34, 1
    s_and_b32 s45, s34, 1
    s_cmp_eq_u32 s34, 0
    s_cbranch_scc0 L_5
    s_mov_b32 exec_lo, -1
    s_mov_b32 exec_hi, 0
    v_mov_b32 v31, 0
    v_mov_b32 v32, 2
    v_mov_b32 v33, 4
    v_mov_b32 v34, 6
    s_not_b64 exec, exec
    v_mov_b32 v31, 8
    v_mov_b32 v32, 10
    v_mov_b32 v33, 12
    v_mov_b32 v34, 14
    s_mov_b64 exec, -1
    s_branch L_4
L_5:
    s_cmp_eq_u32 s34, 1
    s_cbranch_scc0 L_6
    s_mov_b32 exec_lo, -1
    s_mov_b32 exec_hi, 0
    v_mov_b32 v31, 512
    v_mov_b32 v32, 516
    v_mov_b32 v33, 520
    v_mov_b32 v34, 524
    s_not_b64 exec, exec
    v_mov_b32 v31, 1024
    v_mov_b32 v32, 1032
    v_mov_b32 v33, 1536
    v_mov_b32 v34, 1544
    s_mov_b64 exec, -1
    s_branch L_4
L_6:
    s_mov_b32 exec_lo, -1
    s_mov_b32 exec_hi, 0
    v_mov_b32 v31, 2048
    v_mov_b32 v32, 2560
    v_mov_b32 v33, 3072
    v_mov_b32 v34, 3584
    s_not_b64 exec, exec
    v_mov_b32 v31, 4096
    v_mov_b32 v32, 4640
    v_mov_b32 v33, 4640
    v_mov_b32 v34, 4640
    s_mov_b64 exec, -1
L_4:
    v_lshlrev_b32 v7, 4, v5
    v_add_u32 v31, v31, v7
    v_add_u32 v32, v32, v7
    v_add_u32 v33, v33, v7
    v_add_u32 v34, v34, v7
    v_lshlrev_b32 v5, 3, v0
    v_sub_u32 v5, 2047, v5
    v_subrev_u32 v6, 0, v5
    v_subrev_u32 v7, 1, v5
    v_cvt_f32_u32 v6, v6
    v_cvt_f32_u32 v7, v7
    v_cvt_pk_bf16_f32 v6, v6, v7
    v_and_b32 v7, 0xffff0000, v6
    v_lshlrev_b32 v6, 16, v6
    v_cvt_u32_f32 v6, v6
    v_cvt_u32_f32 v7, v7
    v_lshlrev_b32 v35, 1, v6
    v_lshlrev_b32 v36, 1, v7
    v_subrev_u32 v6, 2, v5
    v_subrev_u32 v7, 3, v5
    v_cvt_f32_u32 v6, v6
    v_cvt_f32_u32 v7, v7
    v_cvt_pk_bf16_f32 v6, v6, v7
    v_and_b32 v7, 0xffff0000, v6
    v_lshlrev_b32 v6, 16, v6
    v_cvt_u32_f32 v6, v6
    v_cvt_u32_f32 v7, v7
    v_lshlrev_b32 v37, 1, v6
    v_lshlrev_b32 v38, 1, v7
    v_subrev_u32 v6, 4, v5
    v_subrev_u32 v7, 5, v5
    v_cvt_f32_u32 v6, v6
    v_cvt_f32_u32 v7, v7
    v_cvt_pk_bf16_f32 v6, v6, v7
    v_and_b32 v7, 0xffff0000, v6
    v_lshlrev_b32 v6, 16, v6
    v_cvt_u32_f32 v6, v6
    v_cvt_u32_f32 v7, v7
    v_lshlrev_b32 v39, 1, v6
    v_lshlrev_b32 v40, 1, v7
    v_subrev_u32 v6, 6, v5
    v_subrev_u32 v7, 7, v5
    v_cvt_f32_u32 v6, v6
    v_cvt_f32_u32 v7, v7
    v_cvt_pk_bf16_f32 v6, v6, v7
    v_and_b32 v7, 0xffff0000, v6
    v_lshlrev_b32 v6, 16, v6
    v_cvt_u32_f32 v6, v6
    v_cvt_u32_f32 v7, v7
    v_lshlrev_b32 v41, 1, v6
    v_lshlrev_b32 v42, 1, v7
    v_lshrrev_b32 v5, 4, v1
    v_and_b32 v6, 15, v1
    v_lshrrev_b32 v7, 2, v6
    v_lshl_add_u32 v7, v5, 3, v7
    v_lshlrev_b32 v43, 7, v7
    v_and_b32 v7, 3, v6
    v_lshl_add_u32 v43, v7, 3, v43
    s_lshl_b32 s46, s34, 5
    s_add_u32 s46, s46, 67072
    v_add_u32 v43, s46, v43
    v_lshlrev_b32 v44, 12, v6
    v_lshl_add_u32 v44, v5, 4, v44
    s_waitcnt lgkmcnt(0)
    s_lshl_b32 s46, s35, 16
    s_and_b32 s47, s35, 0xffff0000
    v_mov_b32 v5, s46
    v_mov_b32 v6, s47
    v_mul_f32 v50, s40, v5
    v_fma_f32 v51, v5, s40, -v50
    v_fmac_f32 v51, s41, v5
    v_exp_f32 v50, v50
    v_mul_f32 v51, s42, v51
    v_fma_f32 v50, v50, v51, v50
    v_cvt_pk_bf16_f32 v50, v50, v50
    v_lshlrev_b32 v49, 16, v50
    v_mul_f32 v52, s40, v6
    v_fma_f32 v53, v6, s40, -v52
    v_fmac_f32 v53, s41, v6
    v_exp_f32 v52, v52
    v_mul_f32 v53, s42, v53
    v_fma_f32 v52, v52, v53, v52
    v_cvt_pk_bf16_f32 v52, v52, v52
    v_lshlrev_b32 v50, 16, v52
    s_waitcnt vmcnt(2)
    v_lshlrev_b32 v8, 16, v8
    v_lshlrev_b32 v9, 16, v9
    v_lshlrev_b32 v10, 16, v10
    v_lshlrev_b32 v11, 16, v11
    v_mul_f32 v68, s40, v8
    v_fma_f32 v69, v8, s40, -v68
    v_fmac_f32 v69, s41, v8
    v_exp_f32 v68, v68
    v_mul_f32 v69, s42, v69
    v_fma_f32 v68, v68, v69, v68
    v_cvt_pk_bf16_f32 v68, v68, v68
    v_lshlrev_b32 v52, 16, v68
    v_mul_f32 v52, v52, v49
    v_mul_f32 v53, v9, v49
    v_mul_f32 v54, v10, v49
    v_mul_f32 v55, v11, v49
    v_add_f32 v54, v54, v54
    v_add_f32 v55, v55, v55
    v_mul_f32 v52, s40, v52
    v_mul_f32 v53, s43, v53
    v_mul_f32 v68, 0xbf800000, v52
    v_mul_f32 v69, 0x3f800000, v53
    v_exp_f32 v68, v68
    v_fract_f32 v69, v69
    s_nop 0
    v_cos_f32 v56, v69
    v_sin_f32 v57, v69
    s_nop 0
    v_mul_f32 v56, v68, v56
    v_mul_f32 v57, v68, v57
    v_mul_f32 v68, 0xc1000000, v52
    v_mul_f32 v69, 0x41000000, v53
    v_exp_f32 v68, v68
    v_fract_f32 v69, v69
    s_nop 0
    v_cos_f32 v58, v69
    v_sin_f32 v59, v69
    s_nop 0
    v_mul_f32 v58, v68, v58
    v_mul_f32 v59, v68, v59
    v_mul_f32 v68, 0xc3800000, v52
    v_mul_f32 v69, 0x43800000, v53
    v_exp_f32 v68, v68
    v_fract_f32 v69, v69
    s_nop 0
    v_cos_f32 v60, v69
    v_sin_f32 v61, v69
    s_nop 0
    v_mul_f32 v60, v68, v60
    v_mul_f32 v61, v68, v61
    v_mul_f32 v62, v56, v56
    v_mul_f32 v63, v57, v56
    v_fma_f32 v62, -v57, v57, v62
    v_fma_f32 v63, v56, v57, v63
    v_mul_f32 v66, v58, v58
    v_mul_f32 v67, v59, v58
    v_fma_f32 v66, -v59, v59, v66
    v_fma_f32 v67, v58, v59, v67
    v_mul_f32 v64, v62, v62
    v_mul_f32 v65, v63, v62
    v_fma_f32 v64, -v63, v63, v64
    v_fma_f32 v65, v62, v63, v65
    v_mov_b32 v70, 1.0
    v_mov_b32 v71, 0
    v_cvt_pk_bf16_f32 v80, v70, v71
    ds_write_b32 v28, v80 offset:0
    v_cvt_pk_bf16_f32 v81, v58, v59
    ds_write_b32 v28, v81 offset:272
    v_cvt_pk_bf16_f32 v84, v54, -v55
    ds_write_b32 v28, v84 offset:8704
    v_mul_f32 v72, v70, v66
    v_mul_f32 v73, v71, v66
    v_fma_f32 v72, -v71, v67, v72
    v_fma_f32 v73, v70, v67, v73
    v_cvt_pk_bf16_f32 v82, v72, v73
    ds_write_b32 v28, v82 offset:544
    v_mul_f32 v76, v58, v66
    v_mul_f32 v77, v59, v66
    v_fma_f32 v76, -v59, v67, v76
    v_fma_f32 v77, v58, v67, v77
    v_cvt_pk_bf16_f32 v83, v76, v77
    ds_write_b32 v28, v83 offset:816
    v_mul_f32 v90, v54, v56
    v_mul_f32 v91, v55, v56
    v_fma_f32 v90, -v55, v57, v90
    v_fma_f32 v91, v54, v57, v91
    v_cvt_pk_bf16_f32 v85, v90, -v91
    ds_write_b32 v28, v85 offset:8976
    v_mul_f32 v70, v72, v66
    v_mul_f32 v71, v73, v66
    v_fma_f32 v70, -v73, v67, v70
    v_fma_f32 v71, v72, v67, v71
    v_cvt_pk_bf16_f32 v80, v70, v71
    ds_write_b32 v28, v80 offset:1088
    v_mul_f32 v74, v76, v66
    v_mul_f32 v75, v77, v66
    v_fma_f32 v74, -v77, v67, v74
    v_fma_f32 v75, v76, v67, v75
    v_cvt_pk_bf16_f32 v81, v74, v75
    ds_write_b32 v28, v81 offset:1360
    v_mul_f32 v88, v90, v56
    v_mul_f32 v89, v91, v56
    v_fma_f32 v88, -v91, v57, v88
    v_fma_f32 v89, v90, v57, v89
    v_cvt_pk_bf16_f32 v86, v88, -v89
    ds_write_b32 v28, v86 offset:9248
    v_mul_f32 v72, v70, v66
    v_mul_f32 v73, v71, v66
    v_fma_f32 v72, -v71, v67, v72
    v_fma_f32 v73, v70, v67, v73
    v_cvt_pk_bf16_f32 v82, v72, v73
    ds_write_b32 v28, v82 offset:1632
    v_mul_f32 v76, v74, v66
    v_mul_f32 v77, v75, v66
    v_fma_f32 v76, -v75, v67, v76
    v_fma_f32 v77, v74, v67, v77
    v_cvt_pk_bf16_f32 v83, v76, v77
    ds_write_b32 v28, v83 offset:1904
    v_mul_f32 v90, v88, v56
    v_mul_f32 v91, v89, v56
    v_fma_f32 v90, -v89, v57, v90
    v_fma_f32 v91, v88, v57, v91
    v_cvt_pk_bf16_f32 v87, v90, -v91
    ds_write_b32 v28, v87 offset:9520
    v_mul_f32 v70, v72, v66
    v_mul_f32 v71, v73, v66
    v_fma_f32 v70, -v73, v67, v70
    v_fma_f32 v71, v72, v67, v71
    v_cvt_pk_bf16_f32 v80, v70, v71
    ds_write_b32 v28, v80 offset:2176
    v_mul_f32 v74, v76, v66
    v_mul_f32 v75, v77, v66
    v_fma_f32 v74, -v77, v67, v74
    v_fma_f32 v75, v76, v67, v75
    v_cvt_pk_bf16_f32 v81, v74, v75
    ds_write_b32 v28, v81 offset:2448
    v_mul_f32 v88, v90, v56
    v_mul_f32 v89, v91, v56
    v_fma_f32 v88, -v91, v57, v88
    v_fma_f32 v89, v90, v57, v89
    v_cvt_pk_bf16_f32 v84, v88, -v89
    ds_write_b32 v28, v84 offset:9792
    v_mul_f32 v72, v70, v66
    v_mul_f32 v73, v71, v66
    v_fma_f32 v72, -v71, v67, v72
    v_fma_f32 v73, v70, v67, v73
    v_cvt_pk_bf16_f32 v82, v72, v73
    ds_write_b32 v28, v82 offset:2720
    v_mul_f32 v76, v74, v66
    v_mul_f32 v77, v75, v66
    v_fma_f32 v76, -v75, v67, v76
    v_fma_f32 v77, v74, v67, v77
    v_cvt_pk_bf16_f32 v83, v76, v77
    ds_write_b32 v28, v83 offset:2992
    v_mul_f32 v90, v88, v56
    v_mul_f32 v91, v89, v56
    v_fma_f32 v90, -v89, v57, v90
    v_fma_f32 v91, v88, v57, v91
    v_cvt_pk_bf16_f32 v85, v90, -v91
    ds_write_b32 v28, v85 offset:10064
    v_mul_f32 v70, v72, v66
    v_mul_f32 v71, v73, v66
    v_fma_f32 v70, -v73, v67, v70
    v_fma_f32 v71, v72, v67, v71
    v_cvt_pk_bf16_f32 v80, v70, v71
    ds_write_b32 v28, v80 offset:3264
    v_mul_f32 v74, v76, v66
    v_mul_f32 v75, v77, v66
    v_fma_f32 v74, -v77, v67, v74
    v_fma_f32 v75, v76, v67, v75
    v_cvt_pk_bf16_f32 v81, v74, v75
    ds_write_b32 v28, v81 offset:3536
    v_mul_f32 v88, v90, v56
    v_mul_f32 v89, v91, v56
    v_fma_f32 v88, -v91, v57, v88
    v_fma_f32 v89, v90, v57, v89
    v_cvt_pk_bf16_f32 v86, v88, -v89
    ds_write_b32 v28, v86 offset:10336
    v_mul_f32 v72, v70, v66
    v_mul_f32 v73, v71, v66
    v_fma_f32 v72, -v71, v67, v72
    v_fma_f32 v73, v70, v67, v73
    v_cvt_pk_bf16_f32 v82, v72, v73
    ds_write_b32 v28, v82 offset:3808
    v_mul_f32 v76, v74, v66
    v_mul_f32 v77, v75, v66
    v_fma_f32 v76, -v75, v67, v76
    v_fma_f32 v77, v74, v67, v77
    v_cvt_pk_bf16_f32 v83, v76, v77
    ds_write_b32 v28, v83 offset:4080
    v_mul_f32 v90, v88, v56
    v_mul_f32 v91, v89, v56
    v_fma_f32 v90, -v89, v57, v90
    v_fma_f32 v91, v88, v57, v91
    v_cvt_pk_bf16_f32 v87, v90, -v91
    ds_write_b32 v28, v87 offset:10608
    v_mul_f32 v70, v72, v66
    v_mul_f32 v71, v73, v66
    v_fma_f32 v70, -v73, v67, v70
    v_fma_f32 v71, v72, v67, v71
    v_cvt_pk_bf16_f32 v80, v70, v71
    ds_write_b32 v28, v80 offset:4352
    v_mul_f32 v74, v76, v66
    v_mul_f32 v75, v77, v66
    v_fma_f32 v74, -v77, v67, v74
    v_fma_f32 v75, v76, v67, v75
    v_cvt_pk_bf16_f32 v81, v74, v75
    ds_write_b32 v28, v81 offset:4624
    v_mul_f32 v92, v54, v60
    v_mul_f32 v93, v55, v60
    v_fma_f32 v92, -v55, v61, v92
    v_fma_f32 v93, v54, v61, v93
    v_cvt_pk_bf16_f32 v84, v92, -v93
    ds_write_b32 v28, v84 offset:10880
    v_mul_f32 v72, v70, v66
    v_mul_f32 v73, v71, v66
    v_fma_f32 v72, -v71, v67, v72
    v_fma_f32 v73, v70, v67, v73
    v_cvt_pk_bf16_f32 v82, v72, v73
    ds_write_b32 v28, v82 offset:4896
    v_mul_f32 v76, v74, v66
    v_mul_f32 v77, v75, v66
    v_fma_f32 v76, -v75, v67, v76
    v_fma_f32 v77, v74, v67, v77
    v_cvt_pk_bf16_f32 v83, v76, v77
    ds_write_b32 v28, v83 offset:5168
    v_mul_f32 v96, v92, v62
    v_mul_f32 v97, v93, v62
    v_fma_f32 v96, -v93, v63, v96
    v_fma_f32 v97, v92, v63, v97
    v_cvt_pk_bf16_f32 v85, v96, -v97
    ds_write_b32 v28, v85 offset:11152
    v_mul_f32 v70, v72, v66
    v_mul_f32 v71, v73, v66
    v_fma_f32 v70, -v73, v67, v70
    v_fma_f32 v71, v72, v67, v71
    v_cvt_pk_bf16_f32 v80, v70, v71
    ds_write_b32 v28, v80 offset:5440
    v_mul_f32 v74, v76, v66
    v_mul_f32 v75, v77, v66
    v_fma_f32 v74, -v77, v67, v74
    v_fma_f32 v75, v76, v67, v75
    v_cvt_pk_bf16_f32 v81, v74, v75
    ds_write_b32 v28, v81 offset:5712
    v_mul_f32 v98, v96, v62
    v_mul_f32 v99, v97, v62
    v_fma_f32 v98, -v97, v63, v98
    v_fma_f32 v99, v96, v63, v99
    v_cvt_pk_bf16_f32 v86, v98, -v99
    ds_write_b32 v28, v86 offset:11424
    v_mul_f32 v72, v70, v66
    v_mul_f32 v73, v71, v66
    v_fma_f32 v72, -v71, v67, v72
    v_fma_f32 v73, v70, v67, v73
    v_cvt_pk_bf16_f32 v82, v72, v73
    ds_write_b32 v28, v82 offset:5984
    v_mul_f32 v76, v74, v66
    v_mul_f32 v77, v75, v66
    v_fma_f32 v76, -v75, v67, v76
    v_fma_f32 v77, v74, v67, v77
    v_cvt_pk_bf16_f32 v83, v76, v77
    ds_write_b32 v28, v83 offset:6256
    v_mul_f32 v96, v98, v62
    v_mul_f32 v97, v99, v62
    v_fma_f32 v96, -v99, v63, v96
    v_fma_f32 v97, v98, v63, v97
    v_cvt_pk_bf16_f32 v87, v96, -v97
    ds_write_b32 v28, v87 offset:11696
    v_mul_f32 v70, v72, v66
    v_mul_f32 v71, v73, v66
    v_fma_f32 v70, -v73, v67, v70
    v_fma_f32 v71, v72, v67, v71
    v_cvt_pk_bf16_f32 v80, v70, v71
    ds_write_b32 v28, v80 offset:6528
    v_mul_f32 v74, v76, v66
    v_mul_f32 v75, v77, v66
    v_fma_f32 v74, -v77, v67, v74
    v_fma_f32 v75, v76, v67, v75
    v_cvt_pk_bf16_f32 v81, v74, v75
    ds_write_b32 v28, v81 offset:6800
    v_mul_f32 v94, v92, v60
    v_mul_f32 v95, v93, v60
    v_fma_f32 v94, -v93, v61, v94
    v_fma_f32 v95, v92, v61, v95
    v_cvt_pk_bf16_f32 v84, v94, -v95
    ds_write_b32 v28, v84 offset:11968
    v_mul_f32 v72, v70, v66
    v_mul_f32 v73, v71, v66
    v_fma_f32 v72, -v71, v67, v72
    v_fma_f32 v73, v70, v67, v73
    v_cvt_pk_bf16_f32 v82, v72, v73
    ds_write_b32 v28, v82 offset:7072
    v_mul_f32 v76, v74, v66
    v_mul_f32 v77, v75, v66
    v_fma_f32 v76, -v75, v67, v76
    v_fma_f32 v77, v74, v67, v77
    v_cvt_pk_bf16_f32 v83, v76, v77
    ds_write_b32 v28, v83 offset:7344
    v_mul_f32 v96, v94, v64
    v_mul_f32 v97, v95, v64
    v_fma_f32 v96, -v95, v65, v96
    v_fma_f32 v97, v94, v65, v97
    v_cvt_pk_bf16_f32 v85, v96, -v97
    ds_write_b32 v28, v85 offset:12240
    v_mul_f32 v70, v72, v66
    v_mul_f32 v71, v73, v66
    v_fma_f32 v70, -v73, v67, v70
    v_fma_f32 v71, v72, v67, v71
    v_cvt_pk_bf16_f32 v80, v70, v71
    ds_write_b32 v28, v80 offset:7616
    v_mul_f32 v74, v76, v66
    v_mul_f32 v75, v77, v66
    v_fma_f32 v74, -v77, v67, v74
    v_fma_f32 v75, v76, v67, v75
    v_cvt_pk_bf16_f32 v81, v74, v75
    ds_write_b32 v28, v81 offset:7888
    v_mul_f32 v92, v94, v60
    v_mul_f32 v93, v95, v60
    v_fma_f32 v92, -v95, v61, v92
    v_fma_f32 v93, v94, v61, v93
    v_cvt_pk_bf16_f32 v86, v92, -v93
    ds_write_b32 v28, v86 offset:12512
    v_mul_f32 v72, v70, v66
    v_mul_f32 v73, v71, v66
    v_fma_f32 v72, -v71, v67, v72
    v_fma_f32 v73, v70, v67, v73
    v_cvt_pk_bf16_f32 v82, v72, v73
    ds_write_b32 v28, v82 offset:8160
    v_mul_f32 v76, v74, v66
    v_mul_f32 v77, v75, v66
    v_fma_f32 v76, -v75, v67, v76
    v_fma_f32 v77, v74, v67, v77
    v_cvt_pk_bf16_f32 v83, v76, v77
    ds_write_b32 v28, v83 offset:8432
    v_mul_f32 v96, v92, v64
    v_mul_f32 v97, v93, v64
    v_fma_f32 v96, -v93, v65, v96
    v_fma_f32 v97, v92, v65, v97
    v_cvt_pk_bf16_f32 v87, v96, -v97
    ds_write_b32 v28, v87 offset:12784
    v_mul_f32 v94, v92, v60
    v_mul_f32 v95, v93, v60
    v_fma_f32 v94, -v93, v61, v94
    v_fma_f32 v95, v92, v61, v95
    v_cvt_pk_bf16_f32 v84, v94, -v95
    ds_write_b32 v28, v84 offset:13056
    v_mul_f32 v92, v94, v60
    v_mul_f32 v93, v95, v60
    v_fma_f32 v92, -v95, v61, v92
    v_fma_f32 v93, v94, v61, v93
    v_cvt_pk_bf16_f32 v85, v92, -v93
    ds_write_b32 v28, v85 offset:13328
    v_mul_f32 v94, v92, v60
    v_mul_f32 v95, v93, v60
    v_fma_f32 v94, -v93, v61, v94
    v_fma_f32 v95, v92, v61, v95
    v_cvt_pk_bf16_f32 v86, v94, -v95
    ds_write_b32 v28, v86 offset:13600
    v_mul_f32 v92, v94, v60
    v_mul_f32 v93, v95, v60
    v_fma_f32 v92, -v95, v61, v92
    v_fma_f32 v93, v94, v61, v93
    v_cvt_pk_bf16_f32 v87, v92, -v93
    ds_write_b32 v28, v87 offset:13872
    v_mul_f32 v94, v92, v60
    v_mul_f32 v95, v93, v60
    v_fma_f32 v94, -v93, v61, v94
    v_fma_f32 v95, v92, v61, v95
    v_cvt_pk_bf16_f32 v84, v94, -v95
    ds_write_b32 v28, v84 offset:14144
    ds_read_b128 v[56:59], v29 offset:0
    ds_read_b128 v[60:63], v30 offset:0
    ds_read_b128 v[64:67], v29 offset:32
    ds_read_b128 v[68:71], v30 offset:32
    ds_read_b128 v[72:75], v29 offset:64
    ds_read_b128 v[76:79], v30 offset:64
    ds_read_b128 v[80:83], v29 offset:96
    ds_read_b128 v[84:87], v30 offset:96
    ds_read_b128 v[88:91], v29 offset:128
    ds_read_b128 v[92:95], v30 offset:128
    ds_read_b128 v[96:99], v29 offset:160
    ds_read_b128 v[100:103], v30 offset:160
    ds_read_b128 v[104:107], v29 offset:192
    ds_read_b128 v[108:111], v30 offset:192
    s_waitcnt lgkmcnt(12)
    v_mfma_f32_32x32x16_bf16 v[120:135], v[56:59], v[60:63], 0
    ds_read_b128 v[112:115], v29 offset:224
    ds_read_b128 v[116:119], v30 offset:224
    s_waitcnt lgkmcnt(12)
    v_mfma_f32_32x32x16_bf16 v[120:135], v[64:67], v[68:71], v[120:135]
    s_waitcnt lgkmcnt(10)
    v_mfma_f32_32x32x16_bf16 v[120:135], v[72:75], v[76:79], v[120:135]
    s_waitcnt lgkmcnt(8)
    v_mfma_f32_32x32x16_bf16 v[120:135], v[80:83], v[84:87], v[120:135]
    s_waitcnt lgkmcnt(6)
    v_mfma_f32_32x32x16_bf16 v[120:135], v[88:91], v[92:95], v[120:135]
    s_waitcnt lgkmcnt(4)
    v_mfma_f32_32x32x16_bf16 v[120:135], v[96:99], v[100:103], v[120:135]
    s_waitcnt lgkmcnt(2)
    v_mfma_f32_32x32x16_bf16 v[120:135], v[104:107], v[108:111], v[120:135]
    s_waitcnt lgkmcnt(0)
    v_mfma_f32_32x32x16_bf16 v[120:135], v[112:115], v[116:119], v[120:135]
    v_lshlrev_b32 v12, 16, v12
    v_lshlrev_b32 v13, 16, v13
    v_lshlrev_b32 v14, 16, v14
    v_lshlrev_b32 v15, 16, v15
    v_mul_f32 v68, s40, v12
    v_fma_f32 v69, v12, s40, -v68
    v_fmac_f32 v69, s41, v12
    v_exp_f32 v68, v68
    v_mul_f32 v69, s42, v69
    v_fma_f32 v68, v68, v69, v68
    v_cvt_pk_bf16_f32 v68, v68, v68
    v_lshlrev_b32 v52, 16, v68
    v_mul_f32 v52, v52, v50
    v_mul_f32 v53, v13, v50
    v_mul_f32 v54, v14, v50
    v_mul_f32 v55, v15, v50
    v_add_f32 v54, v54, v54
    v_add_f32 v55, v55, v55
    v_mul_f32 v52, s40, v52
    v_mul_f32 v53, s43, v53
    v_mul_f32 v68, 0xbf800000, v52
    v_mul_f32 v69, 0x3f800000, v53
    v_exp_f32 v68, v68
    v_fract_f32 v69, v69
    s_nop 0
    v_cos_f32 v56, v69
    v_sin_f32 v57, v69
    s_nop 0
    v_mul_f32 v56, v68, v56
    v_mul_f32 v57, v68, v57
    v_mul_f32 v68, 0xc1000000, v52
    v_mul_f32 v69, 0x41000000, v53
    v_exp_f32 v68, v68
    v_fract_f32 v69, v69
    s_nop 0
    v_cos_f32 v58, v69
    v_sin_f32 v59, v69
    s_nop 0
    v_mul_f32 v58, v68, v58
    v_mul_f32 v59, v68, v59
    v_mul_f32 v68, 0xc3800000, v52
    v_mul_f32 v69, 0x43800000, v53
    v_exp_f32 v68, v68
    v_fract_f32 v69, v69
    s_nop 0
    v_cos_f32 v60, v69
    v_sin_f32 v61, v69
    s_nop 0
    v_mul_f32 v60, v68, v60
    v_mul_f32 v61, v68, v61
    v_mul_f32 v62, v56, v56
    v_mul_f32 v63, v57, v56
    v_fma_f32 v62, -v57, v57, v62
    v_fma_f32 v63, v56, v57, v63
    v_mul_f32 v66, v58, v58
    v_mul_f32 v67, v59, v58
    v_fma_f32 v66, -v59, v59, v66
    v_fma_f32 v67, v58, v59, v67
    v_mul_f32 v64, v62, v62
    v_mul_f32 v65, v63, v62
    v_fma_f32 v64, -v63, v63, v64
    v_fma_f32 v65, v62, v63, v65
    v_mov_b32 v70, 1.0
    v_mov_b32 v71, 0
    v_cvt_pk_bf16_f32 v80, v70, v71
    ds_write_b32 v28, v80 offset:0
    v_cvt_pk_bf16_f32 v81, v58, v59
    ds_write_b32 v28, v81 offset:272
    v_cvt_pk_bf16_f32 v84, v54, -v55
    ds_write_b32 v28, v84 offset:8704
    v_mul_f32 v72, v70, v66
    v_mul_f32 v73, v71, v66
    v_fma_f32 v72, -v71, v67, v72
    v_fma_f32 v73, v70, v67, v73
    v_cvt_pk_bf16_f32 v82, v72, v73
    ds_write_b32 v28, v82 offset:544
    v_mul_f32 v76, v58, v66
    v_mul_f32 v77, v59, v66
    v_fma_f32 v76, -v59, v67, v76
    v_fma_f32 v77, v58, v67, v77
    v_cvt_pk_bf16_f32 v83, v76, v77
    ds_write_b32 v28, v83 offset:816
    v_mul_f32 v90, v54, v56
    v_mul_f32 v91, v55, v56
    v_fma_f32 v90, -v55, v57, v90
    v_fma_f32 v91, v54, v57, v91
    v_cvt_pk_bf16_f32 v85, v90, -v91
    ds_write_b32 v28, v85 offset:8976
    v_mul_f32 v70, v72, v66
    v_mul_f32 v71, v73, v66
    v_fma_f32 v70, -v73, v67, v70
    v_fma_f32 v71, v72, v67, v71
    v_cvt_pk_bf16_f32 v80, v70, v71
    ds_write_b32 v28, v80 offset:1088
    v_mul_f32 v74, v76, v66
    v_mul_f32 v75, v77, v66
    v_fma_f32 v74, -v77, v67, v74
    v_fma_f32 v75, v76, v67, v75
    v_cvt_pk_bf16_f32 v81, v74, v75
    ds_write_b32 v28, v81 offset:1360
    v_mul_f32 v88, v90, v56
    v_mul_f32 v89, v91, v56
    v_fma_f32 v88, -v91, v57, v88
    v_fma_f32 v89, v90, v57, v89
    v_cvt_pk_bf16_f32 v86, v88, -v89
    ds_write_b32 v28, v86 offset:9248
    v_mul_f32 v72, v70, v66
    v_mul_f32 v73, v71, v66
    v_fma_f32 v72, -v71, v67, v72
    v_fma_f32 v73, v70, v67, v73
    v_cvt_pk_bf16_f32 v82, v72, v73
    ds_write_b32 v28, v82 offset:1632
    v_mul_f32 v76, v74, v66
    v_mul_f32 v77, v75, v66
    v_fma_f32 v76, -v75, v67, v76
    v_fma_f32 v77, v74, v67, v77
    v_cvt_pk_bf16_f32 v83, v76, v77
    ds_write_b32 v28, v83 offset:1904
    v_mul_f32 v90, v88, v56
    v_mul_f32 v91, v89, v56
    v_fma_f32 v90, -v89, v57, v90
    v_fma_f32 v91, v88, v57, v91
    v_cvt_pk_bf16_f32 v87, v90, -v91
    ds_write_b32 v28, v87 offset:9520
    v_mul_f32 v70, v72, v66
    v_mul_f32 v71, v73, v66
    v_fma_f32 v70, -v73, v67, v70
    v_fma_f32 v71, v72, v67, v71
    v_cvt_pk_bf16_f32 v80, v70, v71
    ds_write_b32 v28, v80 offset:2176
    v_mul_f32 v74, v76, v66
    v_mul_f32 v75, v77, v66
    v_fma_f32 v74, -v77, v67, v74
    v_fma_f32 v75, v76, v67, v75
    v_cvt_pk_bf16_f32 v81, v74, v75
    ds_write_b32 v28, v81 offset:2448
    v_mul_f32 v88, v90, v56
    v_mul_f32 v89, v91, v56
    v_fma_f32 v88, -v91, v57, v88
    v_fma_f32 v89, v90, v57, v89
    v_cvt_pk_bf16_f32 v84, v88, -v89
    ds_write_b32 v28, v84 offset:9792
    v_mul_f32 v72, v70, v66
    v_mul_f32 v73, v71, v66
    v_fma_f32 v72, -v71, v67, v72
    v_fma_f32 v73, v70, v67, v73
    v_cvt_pk_bf16_f32 v82, v72, v73
    ds_write_b32 v28, v82 offset:2720
    v_mul_f32 v76, v74, v66
    v_mul_f32 v77, v75, v66
    v_fma_f32 v76, -v75, v67, v76
    v_fma_f32 v77, v74, v67, v77
    v_cvt_pk_bf16_f32 v83, v76, v77
    ds_write_b32 v28, v83 offset:2992
    v_mul_f32 v90, v88, v56
    v_mul_f32 v91, v89, v56
    v_fma_f32 v90, -v89, v57, v90
    v_fma_f32 v91, v88, v57, v91
    v_cvt_pk_bf16_f32 v85, v90, -v91
    ds_write_b32 v28, v85 offset:10064
    v_mul_f32 v70, v72, v66
    v_mul_f32 v71, v73, v66
    v_fma_f32 v70, -v73, v67, v70
    v_fma_f32 v71, v72, v67, v71
    v_cvt_pk_bf16_f32 v80, v70, v71
    ds_write_b32 v28, v80 offset:3264
    v_mul_f32 v74, v76, v66
    v_mul_f32 v75, v77, v66
    v_fma_f32 v74, -v77, v67, v74
    v_fma_f32 v75, v76, v67, v75
    v_cvt_pk_bf16_f32 v81, v74, v75
    ds_write_b32 v28, v81 offset:3536
    v_mul_f32 v88, v90, v56
    v_mul_f32 v89, v91, v56
    v_fma_f32 v88, -v91, v57, v88
    v_fma_f32 v89, v90, v57, v89
    v_cvt_pk_bf16_f32 v86, v88, -v89
    ds_write_b32 v28, v86 offset:10336
    v_mul_f32 v72, v70, v66
    v_mul_f32 v73, v71, v66
    v_fma_f32 v72, -v71, v67, v72
    v_fma_f32 v73, v70, v67, v73
    v_cvt_pk_bf16_f32 v82, v72, v73
    ds_write_b32 v28, v82 offset:3808
    v_mul_f32 v76, v74, v66
    v_mul_f32 v77, v75, v66
    v_fma_f32 v76, -v75, v67, v76
    v_fma_f32 v77, v74, v67, v77
    v_cvt_pk_bf16_f32 v83, v76, v77
    ds_write_b32 v28, v83 offset:4080
    v_mul_f32 v90, v88, v56
    v_mul_f32 v91, v89, v56
    v_fma_f32 v90, -v89, v57, v90
    v_fma_f32 v91, v88, v57, v91
    v_cvt_pk_bf16_f32 v87, v90, -v91
    ds_write_b32 v28, v87 offset:10608
    v_mul_f32 v70, v72, v66
    v_mul_f32 v71, v73, v66
    v_fma_f32 v70, -v73, v67, v70
    v_fma_f32 v71, v72, v67, v71
    v_cvt_pk_bf16_f32 v80, v70, v71
    ds_write_b32 v28, v80 offset:4352
    v_mul_f32 v74, v76, v66
    v_mul_f32 v75, v77, v66
    v_fma_f32 v74, -v77, v67, v74
    v_fma_f32 v75, v76, v67, v75
    v_cvt_pk_bf16_f32 v81, v74, v75
    ds_write_b32 v28, v81 offset:4624
    v_mul_f32 v92, v54, v60
    v_mul_f32 v93, v55, v60
    v_fma_f32 v92, -v55, v61, v92
    v_fma_f32 v93, v54, v61, v93
    v_cvt_pk_bf16_f32 v84, v92, -v93
    ds_write_b32 v28, v84 offset:10880
    v_mul_f32 v72, v70, v66
    v_mul_f32 v73, v71, v66
    v_fma_f32 v72, -v71, v67, v72
    v_fma_f32 v73, v70, v67, v73
    v_cvt_pk_bf16_f32 v82, v72, v73
    ds_write_b32 v28, v82 offset:4896
    v_mul_f32 v76, v74, v66
    v_mul_f32 v77, v75, v66
    v_fma_f32 v76, -v75, v67, v76
    v_fma_f32 v77, v74, v67, v77
    v_cvt_pk_bf16_f32 v83, v76, v77
    ds_write_b32 v28, v83 offset:5168
    v_mul_f32 v96, v92, v62
    v_mul_f32 v97, v93, v62
    v_fma_f32 v96, -v93, v63, v96
    v_fma_f32 v97, v92, v63, v97
    v_cvt_pk_bf16_f32 v85, v96, -v97
    ds_write_b32 v28, v85 offset:11152
    v_mul_f32 v70, v72, v66
    v_mul_f32 v71, v73, v66
    v_fma_f32 v70, -v73, v67, v70
    v_fma_f32 v71, v72, v67, v71
    v_cvt_pk_bf16_f32 v80, v70, v71
    ds_write_b32 v28, v80 offset:5440
    v_mul_f32 v74, v76, v66
    v_mul_f32 v75, v77, v66
    v_fma_f32 v74, -v77, v67, v74
    v_fma_f32 v75, v76, v67, v75
    v_cvt_pk_bf16_f32 v81, v74, v75
    ds_write_b32 v28, v81 offset:5712
    v_mul_f32 v98, v96, v62
    v_mul_f32 v99, v97, v62
    v_fma_f32 v98, -v97, v63, v98
    v_fma_f32 v99, v96, v63, v99
    v_cvt_pk_bf16_f32 v86, v98, -v99
    ds_write_b32 v28, v86 offset:11424
    v_mul_f32 v72, v70, v66
    v_mul_f32 v73, v71, v66
    v_fma_f32 v72, -v71, v67, v72
    v_fma_f32 v73, v70, v67, v73
    v_cvt_pk_bf16_f32 v82, v72, v73
    ds_write_b32 v28, v82 offset:5984
    v_mul_f32 v76, v74, v66
    v_mul_f32 v77, v75, v66
    v_fma_f32 v76, -v75, v67, v76
    v_fma_f32 v77, v74, v67, v77
    v_cvt_pk_bf16_f32 v83, v76, v77
    ds_write_b32 v28, v83 offset:6256
    v_mul_f32 v96, v98, v62
    v_mul_f32 v97, v99, v62
    v_fma_f32 v96, -v99, v63, v96
    v_fma_f32 v97, v98, v63, v97
    v_cvt_pk_bf16_f32 v87, v96, -v97
    ds_write_b32 v28, v87 offset:11696
    v_mul_f32 v70, v72, v66
    v_mul_f32 v71, v73, v66
    v_fma_f32 v70, -v73, v67, v70
    v_fma_f32 v71, v72, v67, v71
    v_cvt_pk_bf16_f32 v80, v70, v71
    ds_write_b32 v28, v80 offset:6528
    v_mul_f32 v74, v76, v66
    v_mul_f32 v75, v77, v66
    v_fma_f32 v74, -v77, v67, v74
    v_fma_f32 v75, v76, v67, v75
    v_cvt_pk_bf16_f32 v81, v74, v75
    ds_write_b32 v28, v81 offset:6800
    v_mul_f32 v94, v92, v60
    v_mul_f32 v95, v93, v60
    v_fma_f32 v94, -v93, v61, v94
    v_fma_f32 v95, v92, v61, v95
    v_cvt_pk_bf16_f32 v84, v94, -v95
    ds_write_b32 v28, v84 offset:11968
    v_mul_f32 v72, v70, v66
    v_mul_f32 v73, v71, v66
    v_fma_f32 v72, -v71, v67, v72
    v_fma_f32 v73, v70, v67, v73
    v_cvt_pk_bf16_f32 v82, v72, v73
    ds_write_b32 v28, v82 offset:7072
    v_mul_f32 v76, v74, v66
    v_mul_f32 v77, v75, v66
    v_fma_f32 v76, -v75, v67, v76
    v_fma_f32 v77, v74, v67, v77
    v_cvt_pk_bf16_f32 v83, v76, v77
    ds_write_b32 v28, v83 offset:7344
    v_mul_f32 v96, v94, v64
    v_mul_f32 v97, v95, v64
    v_fma_f32 v96, -v95, v65, v96
    v_fma_f32 v97, v94, v65, v97
    v_cvt_pk_bf16_f32 v85, v96, -v97
    ds_write_b32 v28, v85 offset:12240
    v_mul_f32 v70, v72, v66
    v_mul_f32 v71, v73, v66
    v_fma_f32 v70, -v73, v67, v70
    v_fma_f32 v71, v72, v67, v71
    v_cvt_pk_bf16_f32 v80, v70, v71
    ds_write_b32 v28, v80 offset:7616
    v_mul_f32 v74, v76, v66
    v_mul_f32 v75, v77, v66
    v_fma_f32 v74, -v77, v67, v74
    v_fma_f32 v75, v76, v67, v75
    v_cvt_pk_bf16_f32 v81, v74, v75
    ds_write_b32 v28, v81 offset:7888
    v_mul_f32 v92, v94, v60
    v_mul_f32 v93, v95, v60
    v_fma_f32 v92, -v95, v61, v92
    v_fma_f32 v93, v94, v61, v93
    v_cvt_pk_bf16_f32 v86, v92, -v93
    ds_write_b32 v28, v86 offset:12512
    v_mul_f32 v72, v70, v66
    v_mul_f32 v73, v71, v66
    v_fma_f32 v72, -v71, v67, v72
    v_fma_f32 v73, v70, v67, v73
    v_cvt_pk_bf16_f32 v82, v72, v73
    ds_write_b32 v28, v82 offset:8160
    v_mul_f32 v76, v74, v66
    v_mul_f32 v77, v75, v66
    v_fma_f32 v76, -v75, v67, v76
    v_fma_f32 v77, v74, v67, v77
    v_cvt_pk_bf16_f32 v83, v76, v77
    ds_write_b32 v28, v83 offset:8432
    v_mul_f32 v96, v92, v64
    v_mul_f32 v97, v93, v64
    v_fma_f32 v96, -v93, v65, v96
    v_fma_f32 v97, v92, v65, v97
    v_cvt_pk_bf16_f32 v87, v96, -v97
    ds_write_b32 v28, v87 offset:12784
    v_mul_f32 v94, v92, v60
    v_mul_f32 v95, v93, v60
    v_fma_f32 v94, -v93, v61, v94
    v_fma_f32 v95, v92, v61, v95
    v_cvt_pk_bf16_f32 v84, v94, -v95
    ds_write_b32 v28, v84 offset:13056
    v_mul_f32 v92, v94, v60
    v_mul_f32 v93, v95, v60
    v_fma_f32 v92, -v95, v61, v92
    v_fma_f32 v93, v94, v61, v93
    v_cvt_pk_bf16_f32 v85, v92, -v93
    ds_write_b32 v28, v85 offset:13328
    v_mul_f32 v94, v92, v60
    v_mul_f32 v95, v93, v60
    v_fma_f32 v94, -v93, v61, v94
    v_fma_f32 v95, v92, v61, v95
    v_cvt_pk_bf16_f32 v86, v94, -v95
    ds_write_b32 v28, v86 offset:13600
    v_mul_f32 v92, v94, v60
    v_mul_f32 v93, v95, v60
    v_fma_f32 v92, -v95, v61, v92
    v_fma_f32 v93, v94, v61, v93
    v_cvt_pk_bf16_f32 v87, v92, -v93
    ds_write_b32 v28, v87 offset:13872
    v_mul_f32 v94, v92, v60
    v_mul_f32 v95, v93, v60
    v_fma_f32 v94, -v93, v61, v94
    v_fma_f32 v95, v92, v61, v95
    v_cvt_pk_bf16_f32 v84, v94, -v95
    ds_write_b32 v28, v84 offset:14144
    ds_read_b128 v[56:59], v29 offset:0
    ds_read_b128 v[60:63], v30 offset:0
    ds_read_b128 v[64:67], v29 offset:32
    ds_read_b128 v[68:71], v30 offset:32
    ds_read_b128 v[72:75], v29 offset:64
    ds_read_b128 v[76:79], v30 offset:64
    ds_read_b128 v[80:83], v29 offset:96
    ds_read_b128 v[84:87], v30 offset:96
    ds_read_b128 v[88:91], v29 offset:128
    ds_read_b128 v[92:95], v30 offset:128
    ds_read_b128 v[96:99], v29 offset:160
    ds_read_b128 v[100:103], v30 offset:160
    ds_read_b128 v[104:107], v29 offset:192
    ds_read_b128 v[108:111], v30 offset:192
    s_waitcnt lgkmcnt(12)
    v_mfma_f32_32x32x16_bf16 v[136:151], v[56:59], v[60:63], 0
    ds_read_b128 v[112:115], v29 offset:224
    ds_read_b128 v[116:119], v30 offset:224
    s_waitcnt lgkmcnt(12)
    v_mfma_f32_32x32x16_bf16 v[136:151], v[64:67], v[68:71], v[136:151]
    s_waitcnt lgkmcnt(10)
    v_mfma_f32_32x32x16_bf16 v[136:151], v[72:75], v[76:79], v[136:151]
    s_waitcnt lgkmcnt(8)
    v_mfma_f32_32x32x16_bf16 v[136:151], v[80:83], v[84:87], v[136:151]
    s_waitcnt lgkmcnt(6)
    v_mfma_f32_32x32x16_bf16 v[136:151], v[88:91], v[92:95], v[136:151]
    s_waitcnt lgkmcnt(4)
    v_mfma_f32_32x32x16_bf16 v[136:151], v[96:99], v[100:103], v[136:151]
    s_waitcnt lgkmcnt(2)
    v_mfma_f32_32x32x16_bf16 v[136:151], v[104:107], v[108:111], v[136:151]
    s_waitcnt lgkmcnt(0)
    v_mfma_f32_32x32x16_bf16 v[136:151], v[112:115], v[116:119], v[136:151]
    s_nop 7
    s_nop 3
    ds_write_b128 v2, v[120:123] offset:0
    ds_write_b128 v2, v[124:127] offset:1024
    ds_write_b128 v2, v[128:131] offset:2048
    ds_write_b128 v2, v[136:139] offset:3072
    ds_write_b128 v2, v[140:143] offset:4096
    ds_write_b128 v2, v[144:147] offset:5120
    s_waitcnt vmcnt(0) lgkmcnt(0)
    s_barrier
    ds_read_b64_tr_b16 v[16:17], v43 offset:0
    ds_read_b64_tr_b16 v[18:19], v43 offset:512
    ds_read_b64_tr_b16 v[20:21], v43 offset:4096
    ds_read_b64_tr_b16 v[22:23], v43 offset:4608
    s_lshl_b32 s3, s53, 2
    s_add_u32 s3, s3, s34
    s_lshl_b32 s3, s3, 16
    s_lshl_b32 s46, s52, 7
    s_add_u32 s3, s3, s46
    s_add_u32 s3, s3, 11534336
    s_waitcnt lgkmcnt(2)
    buffer_store_dwordx4 v[16:19], v44, s[8:11], s3 offen sc1
    s_waitcnt lgkmcnt(0)
    buffer_store_dwordx4 v[20:23], v44, s[8:11], s3 offen offset:64 sc1
    s_cmp_eq_u32 s34, 3
    s_cbranch_scc1 L_8
    ds_read_b128 v[56:59], v3 offset:0
    ds_read_b128 v[60:63], v3 offset:14416
    ds_read_b128 v[64:67], v3 offset:28832
    ds_read_b128 v[68:71], v3 offset:43248
    ds_read_b128 v[72:75], v3 offset:3072
    ds_read_b128 v[76:79], v3 offset:17488
    ds_read_b128 v[80:83], v3 offset:31904
    ds_read_b128 v[84:87], v3 offset:46320
    s_waitcnt lgkmcnt(4)
    v_add_f32 v56, v56, v60
    v_add_f32 v64, v64, v68
    v_add_f32 v57, v57, v61
    v_add_f32 v65, v65, v69
    v_add_f32 v58, v58, v62
    v_add_f32 v66, v66, v70
    v_add_f32 v59, v59, v63
    v_add_f32 v67, v67, v71
    v_add_f32 v56, v56, v64
    v_add_f32 v57, v57, v65
    v_add_f32 v58, v58, v66
    v_add_f32 v59, v59, v67
    v_cvt_pk_bf16_f32 v60, v56, v56
    v_cvt_pk_bf16_f32 v61, v57, v57
    v_cvt_pk_bf16_f32 v62, v58, v58
    v_cvt_pk_bf16_f32 v63, v59, v59
    ds_write_b16 v31, v60 offset:8192
    ds_write_b16 v32, v61 offset:8192
    ds_write_b16 v33, v62 offset:8192
    ds_write_b16 v34, v63 offset:8192
    s_waitcnt lgkmcnt(4)
    v_add_f32 v72, v72, v76
    v_add_f32 v80, v80, v84
    v_add_f32 v73, v73, v77
    v_add_f32 v81, v81, v85
    v_add_f32 v74, v74, v78
    v_add_f32 v82, v82, v86
    v_add_f32 v75, v75, v79
    v_add_f32 v83, v83, v87
    v_add_f32 v72, v72, v80
    v_add_f32 v73, v73, v81
    v_add_f32 v74, v74, v82
    v_add_f32 v75, v75, v83
    v_cvt_pk_bf16_f32 v76, v72, v72
    v_cvt_pk_bf16_f32 v77, v73, v73
    v_cvt_pk_bf16_f32 v78, v74, v74
    v_cvt_pk_bf16_f32 v79, v75, v75
    ds_write_b16 v31, v76 offset:22608
    ds_write_b16 v32, v77 offset:22608
    ds_write_b16 v33, v78 offset:22608
    ds_write_b16 v34, v79 offset:22608
L_8:
    s_waitcnt lgkmcnt(0)
    s_barrier
    ds_read_u16 v100, v35 offset:8192
    ds_read_u16 v101, v36 offset:8192
    ds_read_u16 v102, v37 offset:8192
    ds_read_u16 v103, v38 offset:8192
    ds_read_u16 v104, v39 offset:8192
    ds_read_u16 v105, v40 offset:8192
    ds_read_u16 v106, v41 offset:8192
    ds_read_u16 v107, v42 offset:8192
    ds_read_u16 v108, v35 offset:22608
    ds_read_u16 v109, v36 offset:22608
    ds_read_u16 v110, v37 offset:22608
    ds_read_u16 v111, v38 offset:22608
    ds_read_u16 v112, v39 offset:22608
    ds_read_u16 v113, v40 offset:22608
    ds_read_u16 v114, v41 offset:22608
    s_waitcnt lgkmcnt(7)
    ds_read_u16 v115, v42 offset:22608
    v_lshl_or_b32 v56, v101, 16, v100
    v_lshl_or_b32 v57, v103, 16, v102
    v_lshl_or_b32 v58, v105, 16, v104
    v_lshl_or_b32 v59, v107, 16, v106
    s_lshl_b32 s3, s32, 13
    s_add_u32 s3, s3, 13631488
    buffer_store_dwordx4 v[56:59], v4, s[8:11], s3 offen sc1
    s_waitcnt lgkmcnt(0)
    v_lshl_or_b32 v64, v109, 16, v108
    v_lshl_or_b32 v65, v111, 16, v110
    v_lshl_or_b32 v66, v113, 16, v112
    v_lshl_or_b32 v67, v115, 16, v114
    s_add_u32 s3, s3, 4096
    buffer_store_dwordx4 v[64:67], v4, s[8:11], s3 offen sc1
    s_endpgm
R_2:
    s_sub_u32 s2, s2, 224
    s_load_dwordx2 s[4:5], s[0:1], 0
    s_load_dwordx2 s[8:9], s[0:1], 64
    s_load_dwordx2 s[12:13], s[0:1], 104
    s_and_b32 s16, s2, 3
    s_lshl_b32 s16, s16, 2
    s_lshr_b32 s3, s2, 3
    s_and_b32 s17, s3, 3
    s_add_u32 s16, s16, s17
    s_lshr_b32 s17, s3, 2
    s_and_b32 s3, s2, 4
    s_lshl_b32 s3, s3, 1
    s_add_u32 s17, s17, s3
    v_lshrrev_b32 v1, 6, v0
    v_and_b32 v0, 63, v0
    v_readfirstlane_b32 s18, v1
    s_waitcnt lgkmcnt(0)
    s_mov_b32 s6, 0x1c0000
    s_mov_b32 s7, 0x20000
    s_mov_b32 s10, 0x126000
    s_mov_b32 s11, 0x20000
    s_mov_b32 s14, 0x1000000
    s_mov_b32 s15, 0x20000
    v_lshrrev_b32 v10, 3, v0
    v_mul_u32_u24 v2, 896, v10
    v_lshrrev_b32 v10, 4, v0
    v_xor_b32 v10, v10, v0
    v_and_b32 v10, 7, v10
    v_lshl_add_u32 v2, v10, 4, v2
    v_xor_b32 v3, 64, v2
    s_lshl_b32 s3, s16, 2
    s_add_u32 s3, s3, s18
    s_mul_i32 s19, s3, 32*896
    s_mul_i32 s20, s18, 16*2688
    s_mul_i32 s21, s17, 168
    s_add_u32 s20, s20, s21
    s_lshl_b32 s22, s18, 12
    s_mul_i32 s23, s18, 3072
    s_add_u32 s23, s23, 32768
    v_add_u32 v10, 0, v0
    v_mul_u32_u24 v11, 43691, v10
    v_lshrrev_b32 v11, 19, v11
    v_mul_u32_u24 v12, 12, v11
    v_sub_u32 v10, v10, v12
    v_mul_u32_u24 v11, 2688, v11
    v_lshl_add_u32 v4, v10, 4, v11
    v_add_u32 v10, 64, v0
    v_mul_u32_u24 v11, 43691, v10
    v_lshrrev_b32 v11, 19, v11
    v_mul_u32_u24 v12, 12, v11
    v_sub_u32 v10, v10, v12
    v_mul_u32_u24 v11, 2688, v11
    v_lshl_add_u32 v104, v10, 4, v11
    v_add_u32 v10, 128, v0
    v_mul_u32_u24 v11, 43691, v10
    v_lshrrev_b32 v11, 19, v11
    v_mul_u32_u24 v12, 12, v11
    v_sub_u32 v10, v10, v12
    v_mul_u32_u24 v11, 2688, v11
    v_lshl_add_u32 v105, v10, 4, v11
    s_add_u32 s24, s19, 0
    s_add_u32 m0, s22, 0
    s_nop 0
    buffer_load_dwordx4 v2, s[4:7], s24 offen lds
    s_add_u32 s24, s19, 7168
    s_add_u32 m0, s22, 1024
    s_nop 0
    buffer_load_dwordx4 v3, s[4:7], s24 offen lds
    s_add_u32 s24, s19, 14336
    s_add_u32 m0, s22, 2048
    s_nop 0
    buffer_load_dwordx4 v2, s[4:7], s24 offen lds
    s_add_u32 s24, s19, 21504
    s_add_u32 m0, s22, 3072
    s_nop 0
    buffer_load_dwordx4 v3, s[4:7], s24 offen lds
    s_add_u32 s24, s20, 0
    s_add_u32 m0, s23, 0
    s_nop 0
    buffer_load_dwordx4 v4, s[8:11], s24 offen lds
    s_add_u32 m0, s23, 1024
    s_nop 0
    buffer_load_dwordx4 v104, s[8:11], s24 offen lds
    s_add_u32 m0, s23, 2048
    s_nop 0
    buffer_load_dwordx4 v105, s[8:11], s24 offen lds
    s_add_u32 s24, s19, 128
    s_add_u32 m0, s22, 16384
    s_nop 0
    buffer_load_dwordx4 v2, s[4:7], s24 offen lds
    s_add_u32 s24, s19, 7296
    s_add_u32 m0, s22, 17408
    s_nop 0
    buffer_load_dwordx4 v3, s[4:7], s24 offen lds
    s_add_u32 s24, s19, 14464
    s_add_u32 m0, s22, 18432
    s_nop 0
    buffer_load_dwordx4 v2, s[4:7], s24 offen lds
    s_add_u32 s24, s19, 21632
    s_add_u32 m0, s22, 19456
    s_nop 0
    buffer_load_dwordx4 v3, s[4:7], s24 offen lds
    s_add_u32 s24, s20, 172032
    s_add_u32 m0, s23, 12288
    s_nop 0
    buffer_load_dwordx4 v4, s[8:11], s24 offen lds
    s_add_u32 m0, s23, 13312
    s_nop 0
    buffer_load_dwordx4 v104, s[8:11], s24 offen lds
    s_add_u32 m0, s23, 14336
    s_nop 0
    buffer_load_dwordx4 v105, s[8:11], s24 offen lds
    v_and_b32 v10, 31, v0
    v_lshrrev_b32 v11, 5, v0
    v_lshrrev_b32 v12, 1, v10
    v_and_b32 v12, 7, v12
    v_xor_b32 v12, v12, v11
    v_lshlrev_b32 v12, 4, v12
    v_lshl_add_u32 v5, v10, 7, v12
    v_add_u32 v5, s22, v5
    v_xor_b32 v6, 32, v5
    v_xor_b32 v7, 64, v5
    v_xor_b32 v8, 96, v5
    v_mul_u32_u24 v9, 1536, v11
    v_bfe_u32 v12, v0, 2, 2
    v_mul_u32_u24 v12, 192, v12
    v_add_u32 v9, v9, v12
    v_bfe_u32 v12, v0, 4, 1
    v_lshl_add_u32 v9, v12, 5, v9
    v_and_b32 v12, 3, v0
    v_lshl_add_u32 v9, v12, 3, v9
    v_add_u32 v9, 32768, v9
    s_cmp_eq_u32 s17, 10
    s_cbranch_scc1 L_9
    s_cmp_gt_u32 s17, 10
    s_cbranch_scc1 L_10
    s_waitcnt vmcnt(7)
    s_barrier
    ds_read_b128 v[64:67], v5 offset:0
    ds_read_b128 v[68:71], v6 offset:0
    ds_read_b128 v[72:75], v7 offset:0
    ds_read_b128 v[76:79], v8 offset:0
    ds_read_b64_tr_b16 v[80:81], v9 offset:0
    ds_read_b64_tr_b16 v[82:83], v9 offset:768
    ds_read_b64_tr_b16 v[84:85], v9 offset:56
    ds_read_b64_tr_b16 v[86:87], v9 offset:824
    ds_read_b64_tr_b16 v[88:89], v9 offset:112
    ds_read_b64_tr_b16 v[90:91], v9 offset:880
    s_add_u32 s24, s20, 344064
    s_add_u32 m0, s23, 24576
    s_nop 0
    buffer_load_dwordx4 v4, s[8:11], s24 offen lds
    s_add_u32 m0, s23, 25600
    s_nop 0
    buffer_load_dwordx4 v104, s[8:11], s24 offen lds
    s_add_u32 m0, s23, 26624
    s_nop 0
    buffer_load_dwordx4 v105, s[8:11], s24 offen lds
    s_waitcnt lgkmcnt(6)
    s_add_u32 s24, s19, 256
    s_add_u32 m0, s22, 0
    s_nop 0
    buffer_load_dwordx4 v2, s[4:7], s24 offen lds
    s_add_u32 s24, s19, 7424
    s_add_u32 m0, s22, 1024
    s_nop 0
    buffer_load_dwordx4 v3, s[4:7], s24 offen lds
    s_add_u32 s24, s19, 14592
    s_add_u32 m0, s22, 2048
    s_nop 0
    buffer_load_dwordx4 v2, s[4:7], s24 offen lds
    s_add_u32 s24, s19, 21760
    s_add_u32 m0, s22, 3072
    s_nop 0
    buffer_load_dwordx4 v3, s[4:7], s24 offen lds
    ds_read_b64_tr_b16 v[92:93], v9 offset:3072
    ds_read_b64_tr_b16 v[94:95], v9 offset:3840
    ds_read_b64_tr_b16 v[96:97], v9 offset:3128
    ds_read_b64_tr_b16 v[98:99], v9 offset:3896
    ds_read_b64_tr_b16 v[100:101], v9 offset:3184
    ds_read_b64_tr_b16 v[102:103], v9 offset:3952
    s_waitcnt lgkmcnt(6)
    v_mfma_f32_32x32x16_bf16 v[16:31], v[80:83], v[64:67], 0
    v_mfma_f32_32x32x16_bf16 v[32:47], v[84:87], v[64:67], 0
    v_mfma_f32_32x32x16_bf16 v[48:63], v[88:91], v[64:67], 0
    ds_read_b64_tr_b16 v[80:81], v9 offset:6144
    ds_read_b64_tr_b16 v[82:83], v9 offset:6912
    ds_read_b64_tr_b16 v[84:85], v9 offset:6200
    ds_read_b64_tr_b16 v[86:87], v9 offset:6968
    ds_read_b64_tr_b16 v[88:89], v9 offset:6256
    ds_read_b64_tr_b16 v[90:91], v9 offset:7024
    s_waitcnt lgkmcnt(6)
    v_mfma_f32_32x32x16_bf16 v[16:31], v[92:95], v[68:71], v[16:31]
    v_mfma_f32_32x32x16_bf16 v[32:47], v[96:99], v[68:71], v[32:47]
    v_mfma_f32_32x32x16_bf16 v[48:63], v[100:103], v[68:71], v[48:63]
    ds_read_b64_tr_b16 v[92:93], v9 offset:9216
    ds_read_b64_tr_b16 v[94:95], v9 offset:9984
    ds_read_b64_tr_b16 v[96:97], v9 offset:9272
    ds_read_b64_tr_b16 v[98:99], v9 offset:10040
    ds_read_b64_tr_b16 v[100:101], v9 offset:9328
    ds_read_b64_tr_b16 v[102:103], v9 offset:10096
    s_waitcnt lgkmcnt(6)
    v_mfma_f32_32x32x16_bf16 v[16:31], v[80:83], v[72:75], v[16:31]
    v_mfma_f32_32x32x16_bf16 v[32:47], v[84:87], v[72:75], v[32:47]
    v_mfma_f32_32x32x16_bf16 v[48:63], v[88:91], v[72:75], v[48:63]
    s_waitcnt lgkmcnt(0)
    v_mfma_f32_32x32x16_bf16 v[16:31], v[92:95], v[76:79], v[16:31]
    v_mfma_f32_32x32x16_bf16 v[32:47], v[96:99], v[76:79], v[32:47]
    v_mfma_f32_32x32x16_bf16 v[48:63], v[100:103], v[76:79], v[48:63]
    s_waitcnt vmcnt(7)
    s_barrier
    ds_read_b128 v[64:67], v5 offset:16384
    ds_read_b128 v[68:71], v6 offset:16384
    ds_read_b128 v[72:75], v7 offset:16384
    ds_read_b128 v[76:79], v8 offset:16384
    ds_read_b64_tr_b16 v[80:81], v9 offset:12288
    ds_read_b64_tr_b16 v[82:83], v9 offset:13056
    ds_read_b64_tr_b16 v[84:85], v9 offset:12344
    ds_read_b64_tr_b16 v[86:87], v9 offset:13112
    ds_read_b64_tr_b16 v[88:89], v9 offset:12400
    ds_read_b64_tr_b16 v[90:91], v9 offset:13168
    s_add_u32 s24, s20, 516096
    s_add_u32 m0, s23, 0
    s_nop 0
    buffer_load_dwordx4 v4, s[8:11], s24 offen lds
    s_add_u32 m0, s23, 1024
    s_nop 0
    buffer_load_dwordx4 v104, s[8:11], s24 offen lds
    s_add_u32 m0, s23, 2048
    s_nop 0
    buffer_load_dwordx4 v105, s[8:11], s24 offen lds
    s_waitcnt lgkmcnt(6)
    s_add_u32 s24, s19, 384
    s_add_u32 m0, s22, 16384
    s_nop 0
    buffer_load_dwordx4 v2, s[4:7], s24 offen lds
    s_add_u32 s24, s19, 7552
    s_add_u32 m0, s22, 17408
    s_nop 0
    buffer_load_dwordx4 v3, s[4:7], s24 offen lds
    s_add_u32 s24, s19, 14720
    s_add_u32 m0, s22, 18432
    s_nop 0
    buffer_load_dwordx4 v2, s[4:7], s24 offen lds
    s_add_u32 s24, s19, 21888
    s_add_u32 m0, s22, 19456
    s_nop 0
    buffer_load_dwordx4 v3, s[4:7], s24 offen lds
    ds_read_b64_tr_b16 v[92:93], v9 offset:15360
    ds_read_b64_tr_b16 v[94:95], v9 offset:16128
    ds_read_b64_tr_b16 v[96:97], v9 offset:15416
    ds_read_b64_tr_b16 v[98:99], v9 offset:16184
    ds_read_b64_tr_b16 v[100:101], v9 offset:15472
    ds_read_b64_tr_b16 v[102:103], v9 offset:16240
    s_waitcnt lgkmcnt(6)
    v_mfma_f32_32x32x16_bf16 v[16:31], v[80:83], v[64:67], v[16:31]
    v_mfma_f32_32x32x16_bf16 v[32:47], v[84:87], v[64:67], v[32:47]
    v_mfma_f32_32x32x16_bf16 v[48:63], v[88:91], v[64:67], v[48:63]
    ds_read_b64_tr_b16 v[80:81], v9 offset:18432
    ds_read_b64_tr_b16 v[82:83], v9 offset:19200
    ds_read_b64_tr_b16 v[84:85], v9 offset:18488
    ds_read_b64_tr_b16 v[86:87], v9 offset:19256
    ds_read_b64_tr_b16 v[88:89], v9 offset:18544
    ds_read_b64_tr_b16 v[90:91], v9 offset:19312
    s_waitcnt lgkmcnt(6)
    v_mfma_f32_32x32x16_bf16 v[16:31], v[92:95], v[68:71], v[16:31]
    v_mfma_f32_32x32x16_bf16 v[32:47], v[96:99], v[68:71], v[32:47]
    v_mfma_f32_32x32x16_bf16 v[48:63], v[100:103], v[68:71], v[48:63]
    ds_read_b64_tr_b16 v[92:93], v9 offset:21504
    ds_read_b64_tr_b16 v[94:95], v9 offset:22272
    ds_read_b64_tr_b16 v[96:97], v9 offset:21560
    ds_read_b64_tr_b16 v[98:99], v9 offset:22328
    ds_read_b64_tr_b16 v[100:101], v9 offset:21616
    ds_read_b64_tr_b16 v[102:103], v9 offset:22384
    s_waitcnt lgkmcnt(6)
    v_mfma_f32_32x32x16_bf16 v[16:31], v[80:83], v[72:75], v[16:31]
    v_mfma_f32_32x32x16_bf16 v[32:47], v[84:87], v[72:75], v[32:47]
    v_mfma_f32_32x32x16_bf16 v[48:63], v[88:91], v[72:75], v[48:63]
    s_waitcnt lgkmcnt(0)
    v_mfma_f32_32x32x16_bf16 v[16:31], v[92:95], v[76:79], v[16:31]
    v_mfma_f32_32x32x16_bf16 v[32:47], v[96:99], v[76:79], v[32:47]
    v_mfma_f32_32x32x16_bf16 v[48:63], v[100:103], v[76:79], v[48:63]
    s_waitcnt vmcnt(7)
    s_barrier
    ds_read_b128 v[64:67], v5 offset:0
    ds_read_b128 v[68:71], v6 offset:0
    ds_read_b128 v[72:75], v7 offset:0
    ds_read_b128 v[76:79], v8 offset:0
    ds_read_b64_tr_b16 v[80:81], v9 offset:24576
    ds_read_b64_tr_b16 v[82:83], v9 offset:25344
    ds_read_b64_tr_b16 v[84:85], v9 offset:24632
    ds_read_b64_tr_b16 v[86:87], v9 offset:25400
    ds_read_b64_tr_b16 v[88:89], v9 offset:24688
    ds_read_b64_tr_b16 v[90:91], v9 offset:25456
    s_add_u32 s24, s20, 688128
    s_add_u32 m0, s23, 12288
    s_nop 0
    buffer_load_dwordx4 v4, s[8:11], s24 offen lds
    s_add_u32 m0, s23, 13312
    s_nop 0
    buffer_load_dwordx4 v104, s[8:11], s24 offen lds
    s_add_u32 m0, s23, 14336
    s_nop 0
    buffer_load_dwordx4 v105, s[8:11], s24 offen lds
    s_waitcnt lgkmcnt(6)
    s_add_u32 s24, s19, 512
    s_add_u32 m0, s22, 0
    s_nop 0
    buffer_load_dwordx4 v2, s[4:7], s24 offen lds
    s_add_u32 s24, s19, 7680
    s_add_u32 m0, s22, 1024
    s_nop 0
    buffer_load_dwordx4 v3, s[4:7], s24 offen lds
    s_add_u32 s24, s19, 14848
    s_add_u32 m0, s22, 2048
    s_nop 0
    buffer_load_dwordx4 v2, s[4:7], s24 offen lds
    s_add_u32 s24, s19, 22016
    s_add_u32 m0, s22, 3072
    s_nop 0
    buffer_load_dwordx4 v3, s[4:7], s24 offen lds
    ds_read_b64_tr_b16 v[92:93], v9 offset:27648
    ds_read_b64_tr_b16 v[94:95], v9 offset:28416
    ds_read_b64_tr_b16 v[96:97], v9 offset:27704
    ds_read_b64_tr_b16 v[98:99], v9 offset:28472
    ds_read_b64_tr_b16 v[100:101], v9 offset:27760
    ds_read_b64_tr_b16 v[102:103], v9 offset:28528
    s_waitcnt lgkmcnt(6)
    v_mfma_f32_32x32x16_bf16 v[16:31], v[80:83], v[64:67], v[16:31]
    v_mfma_f32_32x32x16_bf16 v[32:47], v[84:87], v[64:67], v[32:47]
    v_mfma_f32_32x32x16_bf16 v[48:63], v[88:91], v[64:67], v[48:63]
    ds_read_b64_tr_b16 v[80:81], v9 offset:30720
    ds_read_b64_tr_b16 v[82:83], v9 offset:31488
    ds_read_b64_tr_b16 v[84:85], v9 offset:30776
    ds_read_b64_tr_b16 v[86:87], v9 offset:31544
    ds_read_b64_tr_b16 v[88:89], v9 offset:30832
    ds_read_b64_tr_b16 v[90:91], v9 offset:31600
    s_waitcnt lgkmcnt(6)
    v_mfma_f32_32x32x16_bf16 v[16:31], v[92:95], v[68:71], v[16:31]
    v_mfma_f32_32x32x16_bf16 v[32:47], v[96:99], v[68:71], v[32:47]
    v_mfma_f32_32x32x16_bf16 v[48:63], v[100:103], v[68:71], v[48:63]
    ds_read_b64_tr_b16 v[92:93], v9 offset:33792
    ds_read_b64_tr_b16 v[94:95], v9 offset:34560
    ds_read_b64_tr_b16 v[96:97], v9 offset:33848
    ds_read_b64_tr_b16 v[98:99], v9 offset:34616
    ds_read_b64_tr_b16 v[100:101], v9 offset:33904
    ds_read_b64_tr_b16 v[102:103], v9 offset:34672
    s_waitcnt lgkmcnt(6)
    v_mfma_f32_32x32x16_bf16 v[16:31], v[80:83], v[72:75], v[16:31]
    v_mfma_f32_32x32x16_bf16 v[32:47], v[84:87], v[72:75], v[32:47]
    v_mfma_f32_32x32x16_bf16 v[48:63], v[88:91], v[72:75], v[48:63]
    s_waitcnt lgkmcnt(0)
    v_mfma_f32_32x32x16_bf16 v[16:31], v[92:95], v[76:79], v[16:31]
    v_mfma_f32_32x32x16_bf16 v[32:47], v[96:99], v[76:79], v[32:47]
    v_mfma_f32_32x32x16_bf16 v[48:63], v[100:103], v[76:79], v[48:63]
    s_waitcnt vmcnt(7)
    s_barrier
    ds_read_b128 v[64:67], v5 offset:16384
    ds_read_b128 v[68:71], v6 offset:16384
    ds_read_b128 v[72:75], v7 offset:16384
    ds_read_b128 v[76:79], v8 offset:16384
    ds_read_b64_tr_b16 v[80:81], v9 offset:0
    ds_read_b64_tr_b16 v[82:83], v9 offset:768
    ds_read_b64_tr_b16 v[84:85], v9 offset:56
    ds_read_b64_tr_b16 v[86:87], v9 offset:824
    ds_read_b64_tr_b16 v[88:89], v9 offset:112
    ds_read_b64_tr_b16 v[90:91], v9 offset:880
    s_add_u32 s24, s20, 860160
    s_add_u32 m0, s23, 24576
    s_nop 0
    buffer_load_dwordx4 v4, s[8:11], s24 offen lds
    s_add_u32 m0, s23, 25600
    s_nop 0
    buffer_load_dwordx4 v104, s[8:11], s24 offen lds
    s_add_u32 m0, s23, 26624
    s_nop 0
    buffer_load_dwordx4 v105, s[8:11], s24 offen lds
    s_waitcnt lgkmcnt(6)
    s_add_u32 s24, s19, 640
    s_add_u32 m0, s22, 16384
    s_nop 0
    buffer_load_dwordx4 v2, s[4:7], s24 offen lds
    s_add_u32 s24, s19, 7808
    s_add_u32 m0, s22, 17408
    s_nop 0
    buffer_load_dwordx4 v3, s[4:7], s24 offen lds
    s_add_u32 s24, s19, 14976
    s_add_u32 m0, s22, 18432
    s_nop 0
    buffer_load_dwordx4 v2, s[4:7], s24 offen lds
    s_add_u32 s24, s19, 22144
    s_add_u32 m0, s22, 19456
    s_nop 0
    buffer_load_dwordx4 v3, s[4:7], s24 offen lds
    ds_read_b64_tr_b16 v[92:93], v9 offset:3072
    ds_read_b64_tr_b16 v[94:95], v9 offset:3840
    ds_read_b64_tr_b16 v[96:97], v9 offset:3128
    ds_read_b64_tr_b16 v[98:99], v9 offset:3896
    ds_read_b64_tr_b16 v[100:101], v9 offset:3184
    ds_read_b64_tr_b16 v[102:103], v9 offset:3952
    s_waitcnt lgkmcnt(6)
    v_mfma_f32_32x32x16_bf16 v[16:31], v[80:83], v[64:67], v[16:31]
    v_mfma_f32_32x32x16_bf16 v[32:47], v[84:87], v[64:67], v[32:47]
    v_mfma_f32_32x32x16_bf16 v[48:63], v[88:91], v[64:67], v[48:63]
    ds_read_b64_tr_b16 v[80:81], v9 offset:6144
    ds_read_b64_tr_b16 v[82:83], v9 offset:6912
    ds_read_b64_tr_b16 v[84:85], v9 offset:6200
    ds_read_b64_tr_b16 v[86:87], v9 offset:6968
    ds_read_b64_tr_b16 v[88:89], v9 offset:6256
    ds_read_b64_tr_b16 v[90:91], v9 offset:7024
    s_waitcnt lgkmcnt(6)
    v_mfma_f32_32x32x16_bf16 v[16:31], v[92:95], v[68:71], v[16:31]
    v_mfma_f32_32x32x16_bf16 v[32:47], v[96:99], v[68:71], v[32:47]
    v_mfma_f32_32x32x16_bf16 v[48:63], v[100:103], v[68:71], v[48:63]
    ds_read_b64_tr_b16 v[92:93], v9 offset:9216
    ds_read_b64_tr_b16 v[94:95], v9 offset:9984
    ds_read_b64_tr_b16 v[96:97], v9 offset:9272
    ds_read_b64_tr_b16 v[98:99], v9 offset:10040
    ds_read_b64_tr_b16 v[100:101], v9 offset:9328
    ds_read_b64_tr_b16 v[102:103], v9 offset:10096
    s_waitcnt lgkmcnt(6)
    v_mfma_f32_32x32x16_bf16 v[16:31], v[80:83], v[72:75], v[16:31]
    v_mfma_f32_32x32x16_bf16 v[32:47], v[84:87], v[72:75], v[32:47]
    v_mfma_f32_32x32x16_bf16 v[48:63], v[88:91], v[72:75], v[48:63]
    s_waitcnt lgkmcnt(0)
    v_mfma_f32_32x32x16_bf16 v[16:31], v[92:95], v[76:79], v[16:31]
    v_mfma_f32_32x32x16_bf16 v[32:47], v[96:99], v[76:79], v[32:47]
    v_mfma_f32_32x32x16_bf16 v[48:63], v[100:103], v[76:79], v[48:63]
    s_waitcnt vmcnt(7)
    s_barrier
    ds_read_b128 v[64:67], v5 offset:0
    ds_read_b128 v[68:71], v6 offset:0
    ds_read_b128 v[72:75], v7 offset:0
    ds_read_b128 v[76:79], v8 offset:0
    ds_read_b64_tr_b16 v[80:81], v9 offset:12288
    ds_read_b64_tr_b16 v[82:83], v9 offset:13056
    ds_read_b64_tr_b16 v[84:85], v9 offset:12344
    ds_read_b64_tr_b16 v[86:87], v9 offset:13112
    ds_read_b64_tr_b16 v[88:89], v9 offset:12400
    ds_read_b64_tr_b16 v[90:91], v9 offset:13168
    s_add_u32 s24, s20, 1032192
    s_add_u32 m0, s23, 0
    s_nop 0
    buffer_load_dwordx4 v4, s[8:11], s24 offen lds
    s_add_u32 m0, s23, 1024
    s_nop 0
    buffer_load_dwordx4 v104, s[8:11], s24 offen lds
    s_add_u32 m0, s23, 2048
    s_nop 0
    buffer_load_dwordx4 v105, s[8:11], s24 offen lds
    s_waitcnt lgkmcnt(6)
    s_add_u32 s24, s19, 768
    s_add_u32 m0, s22, 0
    s_nop 0
    buffer_load_dwordx4 v2, s[4:7], s24 offen lds
    s_add_u32 s24, s19, 7936
    s_add_u32 m0, s22, 1024
    s_nop 0
    buffer_load_dwordx4 v3, s[4:7], s24 offen lds
    s_add_u32 s24, s19, 15104
    s_add_u32 m0, s22, 2048
    s_nop 0
    buffer_load_dwordx4 v2, s[4:7], s24 offen lds
    s_add_u32 s24, s19, 22272
    s_add_u32 m0, s22, 3072
    s_nop 0
    buffer_load_dwordx4 v3, s[4:7], s24 offen lds
    ds_read_b64_tr_b16 v[92:93], v9 offset:15360
    ds_read_b64_tr_b16 v[94:95], v9 offset:16128
    ds_read_b64_tr_b16 v[96:97], v9 offset:15416
    ds_read_b64_tr_b16 v[98:99], v9 offset:16184
    ds_read_b64_tr_b16 v[100:101], v9 offset:15472
    ds_read_b64_tr_b16 v[102:103], v9 offset:16240
    s_waitcnt lgkmcnt(6)
    v_mfma_f32_32x32x16_bf16 v[16:31], v[80:83], v[64:67], v[16:31]
    v_mfma_f32_32x32x16_bf16 v[32:47], v[84:87], v[64:67], v[32:47]
    v_mfma_f32_32x32x16_bf16 v[48:63], v[88:91], v[64:67], v[48:63]
    ds_read_b64_tr_b16 v[80:81], v9 offset:18432
    ds_read_b64_tr_b16 v[82:83], v9 offset:19200
    ds_read_b64_tr_b16 v[84:85], v9 offset:18488
    ds_read_b64_tr_b16 v[86:87], v9 offset:19256
    ds_read_b64_tr_b16 v[88:89], v9 offset:18544
    ds_read_b64_tr_b16 v[90:91], v9 offset:19312
    s_waitcnt lgkmcnt(6)
    v_mfma_f32_32x32x16_bf16 v[16:31], v[92:95], v[68:71], v[16:31]
    v_mfma_f32_32x32x16_bf16 v[32:47], v[96:99], v[68:71], v[32:47]
    v_mfma_f32_32x32x16_bf16 v[48:63], v[100:103], v[68:71], v[48:63]
    ds_read_b64_tr_b16 v[92:93], v9 offset:21504
    ds_read_b64_tr_b16 v[94:95], v9 offset:22272
    ds_read_b64_tr_b16 v[96:97], v9 offset:21560
    ds_read_b64_tr_b16 v[98:99], v9 offset:22328
    ds_read_b64_tr_b16 v[100:101], v9 offset:21616
    ds_read_b64_tr_b16 v[102:103], v9 offset:22384
    s_waitcnt lgkmcnt(6)
    v_mfma_f32_32x32x16_bf16 v[16:31], v[80:83], v[72:75], v[16:31]
    v_mfma_f32_32x32x16_bf16 v[32:47], v[84:87], v[72:75], v[32:47]
    v_mfma_f32_32x32x16_bf16 v[48:63], v[88:91], v[72:75], v[48:63]
    s_waitcnt lgkmcnt(0)
    v_mfma_f32_32x32x16_bf16 v[16:31], v[92:95], v[76:79], v[16:31]
    v_mfma_f32_32x32x16_bf16 v[32:47], v[96:99], v[76:79], v[32:47]
    v_mfma_f32_32x32x16_bf16 v[48:63], v[100:103], v[76:79], v[48:63]
    s_waitcnt vmcnt(7)
    s_barrier
    ds_read_b128 v[64:67], v5 offset:16384
    ds_read_b128 v[68:71], v6 offset:16384
    ds_read_b128 v[72:75], v7 offset:16384
    ds_read_b128 v[76:79], v8 offset:16384
    ds_read_b64_tr_b16 v[80:81], v9 offset:24576
    ds_read_b64_tr_b16 v[82:83], v9 offset:25344
    ds_read_b64_tr_b16 v[84:85], v9 offset:24632
    ds_read_b64_tr_b16 v[86:87], v9 offset:25400
    ds_read_b64_tr_b16 v[88:89], v9 offset:24688
    ds_read_b64_tr_b16 v[90:91], v9 offset:25456
    s_waitcnt lgkmcnt(6)
    ds_read_b64_tr_b16 v[92:93], v9 offset:27648
    ds_read_b64_tr_b16 v[94:95], v9 offset:28416
    ds_read_b64_tr_b16 v[96:97], v9 offset:27704
    ds_read_b64_tr_b16 v[98:99], v9 offset:28472
    ds_read_b64_tr_b16 v[100:101], v9 offset:27760
    ds_read_b64_tr_b16 v[102:103], v9 offset:28528
    s_waitcnt lgkmcnt(6)
    v_mfma_f32_32x32x16_bf16 v[16:31], v[80:83], v[64:67], v[16:31]
    v_mfma_f32_32x32x16_bf16 v[32:47], v[84:87], v[64:67], v[32:47]
    v_mfma_f32_32x32x16_bf16 v[48:63], v[88:91], v[64:67], v[48:63]
    ds_read_b64_tr_b16 v[80:81], v9 offset:30720
    ds_read_b64_tr_b16 v[82:83], v9 offset:31488
    ds_read_b64_tr_b16 v[84:85], v9 offset:30776
    ds_read_b64_tr_b16 v[86:87], v9 offset:31544
    ds_read_b64_tr_b16 v[88:89], v9 offset:30832
    ds_read_b64_tr_b16 v[90:91], v9 offset:31600
    s_waitcnt lgkmcnt(6)
    v_mfma_f32_32x32x16_bf16 v[16:31], v[92:95], v[68:71], v[16:31]
    v_mfma_f32_32x32x16_bf16 v[32:47], v[96:99], v[68:71], v[32:47]
    v_mfma_f32_32x32x16_bf16 v[48:63], v[100:103], v[68:71], v[48:63]
    ds_read_b64_tr_b16 v[92:93], v9 offset:33792
    ds_read_b64_tr_b16 v[94:95], v9 offset:34560
    ds_read_b64_tr_b16 v[96:97], v9 offset:33848
    ds_read_b64_tr_b16 v[98:99], v9 offset:34616
    ds_read_b64_tr_b16 v[100:101], v9 offset:33904
    ds_read_b64_tr_b16 v[102:103], v9 offset:34672
    s_waitcnt lgkmcnt(6)
    v_mfma_f32_32x32x16_bf16 v[16:31], v[80:83], v[72:75], v[16:31]
    v_mfma_f32_32x32x16_bf16 v[32:47], v[84:87], v[72:75], v[32:47]
    v_mfma_f32_32x32x16_bf16 v[48:63], v[88:91], v[72:75], v[48:63]
    s_waitcnt lgkmcnt(0)
    v_mfma_f32_32x32x16_bf16 v[16:31], v[92:95], v[76:79], v[16:31]
    v_mfma_f32_32x32x16_bf16 v[32:47], v[96:99], v[76:79], v[32:47]
    v_mfma_f32_32x32x16_bf16 v[48:63], v[100:103], v[76:79], v[48:63]
    s_waitcnt vmcnt(0)
    s_barrier
    ds_read_b128 v[64:67], v5 offset:0
    ds_read_b128 v[68:71], v6 offset:0
    ds_read_b128 v[72:75], v7 offset:0
    ds_read_b128 v[76:79], v8 offset:0
    ds_read_b64_tr_b16 v[80:81], v9 offset:0
    ds_read_b64_tr_b16 v[82:83], v9 offset:768
    ds_read_b64_tr_b16 v[84:85], v9 offset:56
    ds_read_b64_tr_b16 v[86:87], v9 offset:824
    ds_read_b64_tr_b16 v[88:89], v9 offset:112
    ds_read_b64_tr_b16 v[90:91], v9 offset:880
    s_waitcnt lgkmcnt(6)
    ds_read_b64_tr_b16 v[92:93], v9 offset:3072
    ds_read_b64_tr_b16 v[94:95], v9 offset:3840
    ds_read_b64_tr_b16 v[96:97], v9 offset:3128
    ds_read_b64_tr_b16 v[98:99], v9 offset:3896
    ds_read_b64_tr_b16 v[100:101], v9 offset:3184
    ds_read_b64_tr_b16 v[102:103], v9 offset:3952
    s_waitcnt lgkmcnt(6)
    v_mfma_f32_32x32x16_bf16 v[16:31], v[80:83], v[64:67], v[16:31]
    v_mfma_f32_32x32x16_bf16 v[32:47], v[84:87], v[64:67], v[32:47]
    v_mfma_f32_32x32x16_bf16 v[48:63], v[88:91], v[64:67], v[48:63]
    ds_read_b64_tr_b16 v[80:81], v9 offset:6144
    ds_read_b64_tr_b16 v[82:83], v9 offset:6912
    ds_read_b64_tr_b16 v[84:85], v9 offset:6200
    ds_read_b64_tr_b16 v[86:87], v9 offset:6968
    ds_read_b64_tr_b16 v[88:89], v9 offset:6256
    ds_read_b64_tr_b16 v[90:91], v9 offset:7024
    s_waitcnt lgkmcnt(6)
    v_mfma_f32_32x32x16_bf16 v[16:31], v[92:95], v[68:71], v[16:31]
    v_mfma_f32_32x32x16_bf16 v[32:47], v[96:99], v[68:71], v[32:47]
    v_mfma_f32_32x32x16_bf16 v[48:63], v[100:103], v[68:71], v[48:63]
    ds_read_b64_tr_b16 v[92:93], v9 offset:9216
    ds_read_b64_tr_b16 v[94:95], v9 offset:9984
    ds_read_b64_tr_b16 v[96:97], v9 offset:9272
    ds_read_b64_tr_b16 v[98:99], v9 offset:10040
    ds_read_b64_tr_b16 v[100:101], v9 offset:9328
    ds_read_b64_tr_b16 v[102:103], v9 offset:10096
    s_waitcnt lgkmcnt(6)
    v_mfma_f32_32x32x16_bf16 v[16:31], v[80:83], v[72:75], v[16:31]
    v_mfma_f32_32x32x16_bf16 v[32:47], v[84:87], v[72:75], v[32:47]
    v_mfma_f32_32x32x16_bf16 v[48:63], v[88:91], v[72:75], v[48:63]
    s_waitcnt lgkmcnt(0)
    v_mfma_f32_32x32x16_bf16 v[16:31], v[92:95], v[76:79], v[16:31]
    v_mfma_f32_32x32x16_bf16 v[32:47], v[96:99], v[76:79], v[32:47]
    v_mfma_f32_32x32x16_bf16 v[48:63], v[100:103], v[76:79], v[48:63]
    s_branch L_11
L_9:
    s_waitcnt vmcnt(7)
    s_barrier
    ds_read_b128 v[64:67], v5 offset:0
    ds_read_b128 v[68:71], v6 offset:0
    ds_read_b128 v[72:75], v7 offset:0
    ds_read_b128 v[76:79], v8 offset:0
    ds_read_b64_tr_b16 v[80:81], v9 offset:0
    ds_read_b64_tr_b16 v[82:83], v9 offset:768
    ds_read_b64_tr_b16 v[84:85], v9 offset:56
    ds_read_b64_tr_b16 v[86:87], v9 offset:824
    ds_read_b64_tr_b16 v[88:89], v9 offset:112
    ds_read_b64_tr_b16 v[90:91], v9 offset:880
    s_add_u32 s24, s20, 344064
    s_add_u32 m0, s23, 24576
    s_nop 0
    buffer_load_dwordx4 v4, s[8:11], s24 offen lds
    s_add_u32 m0, s23, 25600
    s_nop 0
    buffer_load_dwordx4 v104, s[8:11], s24 offen lds
    s_add_u32 m0, s23, 26624
    s_nop 0
    buffer_load_dwordx4 v105, s[8:11], s24 offen lds
    s_waitcnt lgkmcnt(6)
    s_add_u32 s24, s19, 256
    s_add_u32 m0, s22, 0
    s_nop 0
    buffer_load_dwordx4 v2, s[4:7], s24 offen lds
    s_add_u32 s24, s19, 7424
    s_add_u32 m0, s22, 1024
    s_nop 0
    buffer_load_dwordx4 v3, s[4:7], s24 offen lds
    s_add_u32 s24, s19, 14592
    s_add_u32 m0, s22, 2048
    s_nop 0
    buffer_load_dwordx4 v2, s[4:7], s24 offen lds
    s_add_u32 s24, s19, 21760
    s_add_u32 m0, s22, 3072
    s_nop 0
    buffer_load_dwordx4 v3, s[4:7], s24 offen lds
    ds_read_b64_tr_b16 v[92:93], v9 offset:3072
    ds_read_b64_tr_b16 v[94:95], v9 offset:3840
    ds_read_b64_tr_b16 v[96:97], v9 offset:3128
    ds_read_b64_tr_b16 v[98:99], v9 offset:3896
    ds_read_b64_tr_b16 v[100:101], v9 offset:3184
    ds_read_b64_tr_b16 v[102:103], v9 offset:3952
    s_waitcnt lgkmcnt(6)
    v_mfma_f32_32x32x16_bf16 v[16:31], v[80:83], v[64:67], 0
    v_mfma_f32_32x32x16_bf16 v[32:47], v[84:87], v[64:67], 0
    v_mfma_f32_32x32x16_bf16 v[48:63], v[64:67], v[88:91], 0
    ds_read_b64_tr_b16 v[80:81], v9 offset:6144
    ds_read_b64_tr_b16 v[82:83], v9 offset:6912
    ds_read_b64_tr_b16 v[84:85], v9 offset:6200
    ds_read_b64_tr_b16 v[86:87], v9 offset:6968
    ds_read_b64_tr_b16 v[88:89], v9 offset:6256
    ds_read_b64_tr_b16 v[90:91], v9 offset:7024
    s_waitcnt lgkmcnt(6)
    v_mfma_f32_32x32x16_bf16 v[16:31], v[92:95], v[68:71], v[16:31]
    v_mfma_f32_32x32x16_bf16 v[32:47], v[96:99], v[68:71], v[32:47]
    v_mfma_f32_32x32x16_bf16 v[48:63], v[68:71], v[100:103], v[48:63]
    ds_read_b64_tr_b16 v[92:93], v9 offset:9216
    ds_read_b64_tr_b16 v[94:95], v9 offset:9984
    ds_read_b64_tr_b16 v[96:97], v9 offset:9272
    ds_read_b64_tr_b16 v[98:99], v9 offset:10040
    ds_read_b64_tr_b16 v[100:101], v9 offset:9328
    ds_read_b64_tr_b16 v[102:103], v9 offset:10096
    s_waitcnt lgkmcnt(6)
    v_mfma_f32_32x32x16_bf16 v[16:31], v[80:83], v[72:75], v[16:31]
    v_mfma_f32_32x32x16_bf16 v[32:47], v[84:87], v[72:75], v[32:47]
    v_mfma_f32_32x32x16_bf16 v[48:63], v[72:75], v[88:91], v[48:63]
    s_waitcnt lgkmcnt(0)
    v_mfma_f32_32x32x16_bf16 v[16:31], v[92:95], v[76:79], v[16:31]
    v_mfma_f32_32x32x16_bf16 v[32:47], v[96:99], v[76:79], v[32:47]
    v_mfma_f32_32x32x16_bf16 v[48:63], v[76:79], v[100:103], v[48:63]
    s_waitcnt vmcnt(7)
    s_barrier
    ds_read_b128 v[64:67], v5 offset:16384
    ds_read_b128 v[68:71], v6 offset:16384
    ds_read_b128 v[72:75], v7 offset:16384
    ds_read_b128 v[76:79], v8 offset:16384
    ds_read_b64_tr_b16 v[80:81], v9 offset:12288
    ds_read_b64_tr_b16 v[82:83], v9 offset:13056
    ds_read_b64_tr_b16 v[84:85], v9 offset:12344
    ds_read_b64_tr_b16 v[86:87], v9 offset:13112
    ds_read_b64_tr_b16 v[88:89], v9 offset:12400
    ds_read_b64_tr_b16 v[90:91], v9 offset:13168
    s_add_u32 s24, s20, 516096
    s_add_u32 m0, s23, 0
    s_nop 0
    buffer_load_dwordx4 v4, s[8:11], s24 offen lds
    s_add_u32 m0, s23, 1024
    s_nop 0
    buffer_load_dwordx4 v104, s[8:11], s24 offen lds
    s_add_u32 m0, s23, 2048
    s_nop 0
    buffer_load_dwordx4 v105, s[8:11], s24 offen lds
    s_waitcnt lgkmcnt(6)
    s_add_u32 s24, s19, 384
    s_add_u32 m0, s22, 16384
    s_nop 0
    buffer_load_dwordx4 v2, s[4:7], s24 offen lds
    s_add_u32 s24, s19, 7552
    s_add_u32 m0, s22, 17408
    s_nop 0
    buffer_load_dwordx4 v3, s[4:7], s24 offen lds
    s_add_u32 s24, s19, 14720
    s_add_u32 m0, s22, 18432
    s_nop 0
    buffer_load_dwordx4 v2, s[4:7], s24 offen lds
    s_add_u32 s24, s19, 21888
    s_add_u32 m0, s22, 19456
    s_nop 0
    buffer_load_dwordx4 v3, s[4:7], s24 offen lds
    ds_read_b64_tr_b16 v[92:93], v9 offset:15360
    ds_read_b64_tr_b16 v[94:95], v9 offset:16128
    ds_read_b64_tr_b16 v[96:97], v9 offset:15416
    ds_read_b64_tr_b16 v[98:99], v9 offset:16184
    ds_read_b64_tr_b16 v[100:101], v9 offset:15472
    ds_read_b64_tr_b16 v[102:103], v9 offset:16240
    s_waitcnt lgkmcnt(6)
    v_mfma_f32_32x32x16_bf16 v[16:31], v[80:83], v[64:67], v[16:31]
    v_mfma_f32_32x32x16_bf16 v[32:47], v[84:87], v[64:67], v[32:47]
    v_mfma_f32_32x32x16_bf16 v[48:63], v[64:67], v[88:91], v[48:63]
    ds_read_b64_tr_b16 v[80:81], v9 offset:18432
    ds_read_b64_tr_b16 v[82:83], v9 offset:19200
    ds_read_b64_tr_b16 v[84:85], v9 offset:18488
    ds_read_b64_tr_b16 v[86:87], v9 offset:19256
    ds_read_b64_tr_b16 v[88:89], v9 offset:18544
    ds_read_b64_tr_b16 v[90:91], v9 offset:19312
    s_waitcnt lgkmcnt(6)
    v_mfma_f32_32x32x16_bf16 v[16:31], v[92:95], v[68:71], v[16:31]
    v_mfma_f32_32x32x16_bf16 v[32:47], v[96:99], v[68:71], v[32:47]
    v_mfma_f32_32x32x16_bf16 v[48:63], v[68:71], v[100:103], v[48:63]
    ds_read_b64_tr_b16 v[92:93], v9 offset:21504
    ds_read_b64_tr_b16 v[94:95], v9 offset:22272
    ds_read_b64_tr_b16 v[96:97], v9 offset:21560
    ds_read_b64_tr_b16 v[98:99], v9 offset:22328
    ds_read_b64_tr_b16 v[100:101], v9 offset:21616
    ds_read_b64_tr_b16 v[102:103], v9 offset:22384
    s_waitcnt lgkmcnt(6)
    v_mfma_f32_32x32x16_bf16 v[16:31], v[80:83], v[72:75], v[16:31]
    v_mfma_f32_32x32x16_bf16 v[32:47], v[84:87], v[72:75], v[32:47]
    v_mfma_f32_32x32x16_bf16 v[48:63], v[72:75], v[88:91], v[48:63]
    s_waitcnt lgkmcnt(0)
    v_mfma_f32_32x32x16_bf16 v[16:31], v[92:95], v[76:79], v[16:31]
    v_mfma_f32_32x32x16_bf16 v[32:47], v[96:99], v[76:79], v[32:47]
    v_mfma_f32_32x32x16_bf16 v[48:63], v[76:79], v[100:103], v[48:63]
    s_waitcnt vmcnt(7)
    s_barrier
    ds_read_b128 v[64:67], v5 offset:0
    ds_read_b128 v[68:71], v6 offset:0
    ds_read_b128 v[72:75], v7 offset:0
    ds_read_b128 v[76:79], v8 offset:0
    ds_read_b64_tr_b16 v[80:81], v9 offset:24576
    ds_read_b64_tr_b16 v[82:83], v9 offset:25344
    ds_read_b64_tr_b16 v[84:85], v9 offset:24632
    ds_read_b64_tr_b16 v[86:87], v9 offset:25400
    ds_read_b64_tr_b16 v[88:89], v9 offset:24688
    ds_read_b64_tr_b16 v[90:91], v9 offset:25456
    s_add_u32 s24, s20, 688128
    s_add_u32 m0, s23, 12288
    s_nop 0
    buffer_load_dwordx4 v4, s[8:11], s24 offen lds
    s_add_u32 m0, s23, 13312
    s_nop 0
    buffer_load_dwordx4 v104, s[8:11], s24 offen lds
    s_add_u32 m0, s23, 14336
    s_nop 0
    buffer_load_dwordx4 v105, s[8:11], s24 offen lds
    s_waitcnt lgkmcnt(6)
    s_add_u32 s24, s19, 512
    s_add_u32 m0, s22, 0
    s_nop 0
    buffer_load_dwordx4 v2, s[4:7], s24 offen lds
    s_add_u32 s24, s19, 7680
    s_add_u32 m0, s22, 1024
    s_nop 0
    buffer_load_dwordx4 v3, s[4:7], s24 offen lds
    s_add_u32 s24, s19, 14848
    s_add_u32 m0, s22, 2048
    s_nop 0
    buffer_load_dwordx4 v2, s[4:7], s24 offen lds
    s_add_u32 s24, s19, 22016
    s_add_u32 m0, s22, 3072
    s_nop 0
    buffer_load_dwordx4 v3, s[4:7], s24 offen lds
    ds_read_b64_tr_b16 v[92:93], v9 offset:27648
    ds_read_b64_tr_b16 v[94:95], v9 offset:28416
    ds_read_b64_tr_b16 v[96:97], v9 offset:27704
    ds_read_b64_tr_b16 v[98:99], v9 offset:28472
    ds_read_b64_tr_b16 v[100:101], v9 offset:27760
    ds_read_b64_tr_b16 v[102:103], v9 offset:28528
    s_waitcnt lgkmcnt(6)
    v_mfma_f32_32x32x16_bf16 v[16:31], v[80:83], v[64:67], v[16:31]
    v_mfma_f32_32x32x16_bf16 v[32:47], v[84:87], v[64:67], v[32:47]
    v_mfma_f32_32x32x16_bf16 v[48:63], v[64:67], v[88:91], v[48:63]
    ds_read_b64_tr_b16 v[80:81], v9 offset:30720
    ds_read_b64_tr_b16 v[82:83], v9 offset:31488
    ds_read_b64_tr_b16 v[84:85], v9 offset:30776
    ds_read_b64_tr_b16 v[86:87], v9 offset:31544
    ds_read_b64_tr_b16 v[88:89], v9 offset:30832
    ds_read_b64_tr_b16 v[90:91], v9 offset:31600
    s_waitcnt lgkmcnt(6)
    v_mfma_f32_32x32x16_bf16 v[16:31], v[92:95], v[68:71], v[16:31]
    v_mfma_f32_32x32x16_bf16 v[32:47], v[96:99], v[68:71], v[32:47]
    v_mfma_f32_32x32x16_bf16 v[48:63], v[68:71], v[100:103], v[48:63]
    ds_read_b64_tr_b16 v[92:93], v9 offset:33792
    ds_read_b64_tr_b16 v[94:95], v9 offset:34560
    ds_read_b64_tr_b16 v[96:97], v9 offset:33848
    ds_read_b64_tr_b16 v[98:99], v9 offset:34616
    ds_read_b64_tr_b16 v[100:101], v9 offset:33904
    ds_read_b64_tr_b16 v[102:103], v9 offset:34672
    s_waitcnt lgkmcnt(6)
    v_mfma_f32_32x32x16_bf16 v[16:31], v[80:83], v[72:75], v[16:31]
    v_mfma_f32_32x32x16_bf16 v[32:47], v[84:87], v[72:75], v[32:47]
    v_mfma_f32_32x32x16_bf16 v[48:63], v[72:75], v[88:91], v[48:63]
    s_waitcnt lgkmcnt(0)
    v_mfma_f32_32x32x16_bf16 v[16:31], v[92:95], v[76:79], v[16:31]
    v_mfma_f32_32x32x16_bf16 v[32:47], v[96:99], v[76:79], v[32:47]
    v_mfma_f32_32x32x16_bf16 v[48:63], v[76:79], v[100:103], v[48:63]
    s_waitcnt vmcnt(7)
    s_barrier
    ds_read_b128 v[64:67], v5 offset:16384
    ds_read_b128 v[68:71], v6 offset:16384
    ds_read_b128 v[72:75], v7 offset:16384
    ds_read_b128 v[76:79], v8 offset:16384
    ds_read_b64_tr_b16 v[80:81], v9 offset:0
    ds_read_b64_tr_b16 v[82:83], v9 offset:768
    ds_read_b64_tr_b16 v[84:85], v9 offset:56
    ds_read_b64_tr_b16 v[86:87], v9 offset:824
    ds_read_b64_tr_b16 v[88:89], v9 offset:112
    ds_read_b64_tr_b16 v[90:91], v9 offset:880
    s_add_u32 s24, s20, 860160
    s_add_u32 m0, s23, 24576
    s_nop 0
    buffer_load_dwordx4 v4, s[8:11], s24 offen lds
    s_add_u32 m0, s23, 25600
    s_nop 0
    buffer_load_dwordx4 v104, s[8:11], s24 offen lds
    s_add_u32 m0, s23, 26624
    s_nop 0
    buffer_load_dwordx4 v105, s[8:11], s24 offen lds
    s_waitcnt lgkmcnt(6)
    s_add_u32 s24, s19, 640
    s_add_u32 m0, s22, 16384
    s_nop 0
    buffer_load_dwordx4 v2, s[4:7], s24 offen lds
    s_add_u32 s24, s19, 7808
    s_add_u32 m0, s22, 17408
    s_nop 0
    buffer_load_dwordx4 v3, s[4:7], s24 offen lds
    s_add_u32 s24, s19, 14976
    s_add_u32 m0, s22, 18432
    s_nop 0
    buffer_load_dwordx4 v2, s[4:7], s24 offen lds
    s_add_u32 s24, s19, 22144
    s_add_u32 m0, s22, 19456
    s_nop 0
    buffer_load_dwordx4 v3, s[4:7], s24 offen lds
    ds_read_b64_tr_b16 v[92:93], v9 offset:3072
    ds_read_b64_tr_b16 v[94:95], v9 offset:3840
    ds_read_b64_tr_b16 v[96:97], v9 offset:3128
    ds_read_b64_tr_b16 v[98:99], v9 offset:3896
    ds_read_b64_tr_b16 v[100:101], v9 offset:3184
    ds_read_b64_tr_b16 v[102:103], v9 offset:3952
    s_waitcnt lgkmcnt(6)
    v_mfma_f32_32x32x16_bf16 v[16:31], v[80:83], v[64:67], v[16:31]
    v_mfma_f32_32x32x16_bf16 v[32:47], v[84:87], v[64:67], v[32:47]
    v_mfma_f32_32x32x16_bf16 v[48:63], v[64:67], v[88:91], v[48:63]
    ds_read_b64_tr_b16 v[80:81], v9 offset:6144
    ds_read_b64_tr_b16 v[82:83], v9 offset:6912
    ds_read_b64_tr_b16 v[84:85], v9 offset:6200
    ds_read_b64_tr_b16 v[86:87], v9 offset:6968
    ds_read_b64_tr_b16 v[88:89], v9 offset:6256
    ds_read_b64_tr_b16 v[90:91], v9 offset:7024
    s_waitcnt lgkmcnt(6)
    v_mfma_f32_32x32x16_bf16 v[16:31], v[92:95], v[68:71], v[16:31]
    v_mfma_f32_32x32x16_bf16 v[32:47], v[96:99], v[68:71], v[32:47]
    v_mfma_f32_32x32x16_bf16 v[48:63], v[68:71], v[100:103], v[48:63]
    ds_read_b64_tr_b16 v[92:93], v9 offset:9216
    ds_read_b64_tr_b16 v[94:95], v9 offset:9984
    ds_read_b64_tr_b16 v[96:97], v9 offset:9272
    ds_read_b64_tr_b16 v[98:99], v9 offset:10040
    ds_read_b64_tr_b16 v[100:101], v9 offset:9328
    ds_read_b64_tr_b16 v[102:103], v9 offset:10096
    s_waitcnt lgkmcnt(6)
    v_mfma_f32_32x32x16_bf16 v[16:31], v[80:83], v[72:75], v[16:31]
    v_mfma_f32_32x32x16_bf16 v[32:47], v[84:87], v[72:75], v[32:47]
    v_mfma_f32_32x32x16_bf16 v[48:63], v[72:75], v[88:91], v[48:63]
    s_waitcnt lgkmcnt(0)
    v_mfma_f32_32x32x16_bf16 v[16:31], v[92:95], v[76:79], v[16:31]
    v_mfma_f32_32x32x16_bf16 v[32:47], v[96:99], v[76:79], v[32:47]
    v_mfma_f32_32x32x16_bf16 v[48:63], v[76:79], v[100:103], v[48:63]
    s_waitcnt vmcnt(7)
    s_barrier
    ds_read_b128 v[64:67], v5 offset:0
    ds_read_b128 v[68:71], v6 offset:0
    ds_read_b128 v[72:75], v7 offset:0
    ds_read_b128 v[76:79], v8 offset:0
    ds_read_b64_tr_b16 v[80:81], v9 offset:12288
    ds_read_b64_tr_b16 v[82:83], v9 offset:13056
    ds_read_b64_tr_b16 v[84:85], v9 offset:12344
    ds_read_b64_tr_b16 v[86:87], v9 offset:13112
    ds_read_b64_tr_b16 v[88:89], v9 offset:12400
    ds_read_b64_tr_b16 v[90:91], v9 offset:13168
    s_add_u32 s24, s20, 1032192
    s_add_u32 m0, s23, 0
    s_nop 0
    buffer_load_dwordx4 v4, s[8:11], s24 offen lds
    s_add_u32 m0, s23, 1024
    s_nop 0
    buffer_load_dwordx4 v104, s[8:11], s24 offen lds
    s_add_u32 m0, s23, 2048
    s_nop 0
    buffer_load_dwordx4 v105, s[8:11], s24 offen lds
    s_waitcnt lgkmcnt(6)
    s_add_u32 s24, s19, 768
    s_add_u32 m0, s22, 0
    s_nop 0
    buffer_load_dwordx4 v2, s[4:7], s24 offen lds
    s_add_u32 s24, s19, 7936
    s_add_u32 m0, s22, 1024
    s_nop 0
    buffer_load_dwordx4 v3, s[4:7], s24 offen lds
    s_add_u32 s24, s19, 15104
    s_add_u32 m0, s22, 2048
    s_nop 0
    buffer_load_dwordx4 v2, s[4:7], s24 offen lds
    s_add_u32 s24, s19, 22272
    s_add_u32 m0, s22, 3072
    s_nop 0
    buffer_load_dwordx4 v3, s[4:7], s24 offen lds
    ds_read_b64_tr_b16 v[92:93], v9 offset:15360
    ds_read_b64_tr_b16 v[94:95], v9 offset:16128
    ds_read_b64_tr_b16 v[96:97], v9 offset:15416
    ds_read_b64_tr_b16 v[98:99], v9 offset:16184
    ds_read_b64_tr_b16 v[100:101], v9 offset:15472
    ds_read_b64_tr_b16 v[102:103], v9 offset:16240
    s_waitcnt lgkmcnt(6)
    v_mfma_f32_32x32x16_bf16 v[16:31], v[80:83], v[64:67], v[16:31]
    v_mfma_f32_32x32x16_bf16 v[32:47], v[84:87], v[64:67], v[32:47]
    v_mfma_f32_32x32x16_bf16 v[48:63], v[64:67], v[88:91], v[48:63]
    ds_read_b64_tr_b16 v[80:81], v9 offset:18432
    ds_read_b64_tr_b16 v[82:83], v9 offset:19200
    ds_read_b64_tr_b16 v[84:85], v9 offset:18488
    ds_read_b64_tr_b16 v[86:87], v9 offset:19256
    ds_read_b64_tr_b16 v[88:89], v9 offset:18544
    ds_read_b64_tr_b16 v[90:91], v9 offset:19312
    s_waitcnt lgkmcnt(6)
    v_mfma_f32_32x32x16_bf16 v[16:31], v[92:95], v[68:71], v[16:31]
    v_mfma_f32_32x32x16_bf16 v[32:47], v[96:99], v[68:71], v[32:47]
    v_mfma_f32_32x32x16_bf16 v[48:63], v[68:71], v[100:103], v[48:63]
    ds_read_b64_tr_b16 v[92:93], v9 offset:21504
    ds_read_b64_tr_b16 v[94:95], v9 offset:22272
    ds_read_b64_tr_b16 v[96:97], v9 offset:21560
    ds_read_b64_tr_b16 v[98:99], v9 offset:22328
    ds_read_b64_tr_b16 v[100:101], v9 offset:21616
    ds_read_b64_tr_b16 v[102:103], v9 offset:22384
    s_waitcnt lgkmcnt(6)
    v_mfma_f32_32x32x16_bf16 v[16:31], v[80:83], v[72:75], v[16:31]
    v_mfma_f32_32x32x16_bf16 v[32:47], v[84:87], v[72:75], v[32:47]
    v_mfma_f32_32x32x16_bf16 v[48:63], v[72:75], v[88:91], v[48:63]
    s_waitcnt lgkmcnt(0)
    v_mfma_f32_32x32x16_bf16 v[16:31], v[92:95], v[76:79], v[16:31]
    v_mfma_f32_32x32x16_bf16 v[32:47], v[96:99], v[76:79], v[32:47]
    v_mfma_f32_32x32x16_bf16 v[48:63], v[76:79], v[100:103], v[48:63]
    s_waitcnt vmcnt(7)
    s_barrier
    ds_read_b128 v[64:67], v5 offset:16384
    ds_read_b128 v[68:71], v6 offset:16384
    ds_read_b128 v[72:75], v7 offset:16384
    ds_read_b128 v[76:79], v8 offset:16384
    ds_read_b64_tr_b16 v[80:81], v9 offset:24576
    ds_read_b64_tr_b16 v[82:83], v9 offset:25344
    ds_read_b64_tr_b16 v[84:85], v9 offset:24632
    ds_read_b64_tr_b16 v[86:87], v9 offset:25400
    ds_read_b64_tr_b16 v[88:89], v9 offset:24688
    ds_read_b64_tr_b16 v[90:91], v9 offset:25456
    s_waitcnt lgkmcnt(6)
    ds_read_b64_tr_b16 v[92:93], v9 offset:27648
    ds_read_b64_tr_b16 v[94:95], v9 offset:28416
    ds_read_b64_tr_b16 v[96:97], v9 offset:27704
    ds_read_b64_tr_b16 v[98:99], v9 offset:28472
    ds_read_b64_tr_b16 v[100:101], v9 offset:27760
    ds_read_b64_tr_b16 v[102:103], v9 offset:28528
    s_waitcnt lgkmcnt(6)
    v_mfma_f32_32x32x16_bf16 v[16:31], v[80:83], v[64:67], v[16:31]
    v_mfma_f32_32x32x16_bf16 v[32:47], v[84:87], v[64:67], v[32:47]
    v_mfma_f32_32x32x16_bf16 v[48:63], v[64:67], v[88:91], v[48:63]
    ds_read_b64_tr_b16 v[80:81], v9 offset:30720
    ds_read_b64_tr_b16 v[82:83], v9 offset:31488
    ds_read_b64_tr_b16 v[84:85], v9 offset:30776
    ds_read_b64_tr_b16 v[86:87], v9 offset:31544
    ds_read_b64_tr_b16 v[88:89], v9 offset:30832
    ds_read_b64_tr_b16 v[90:91], v9 offset:31600
    s_waitcnt lgkmcnt(6)
    v_mfma_f32_32x32x16_bf16 v[16:31], v[92:95], v[68:71], v[16:31]
    v_mfma_f32_32x32x16_bf16 v[32:47], v[96:99], v[68:71], v[32:47]
    v_mfma_f32_32x32x16_bf16 v[48:63], v[68:71], v[100:103], v[48:63]
    ds_read_b64_tr_b16 v[92:93], v9 offset:33792
    ds_read_b64_tr_b16 v[94:95], v9 offset:34560
    ds_read_b64_tr_b16 v[96:97], v9 offset:33848
    ds_read_b64_tr_b16 v[98:99], v9 offset:34616
    ds_read_b64_tr_b16 v[100:101], v9 offset:33904
    ds_read_b64_tr_b16 v[102:103], v9 offset:34672
    s_waitcnt lgkmcnt(6)
    v_mfma_f32_32x32x16_bf16 v[16:31], v[80:83], v[72:75], v[16:31]
    v_mfma_f32_32x32x16_bf16 v[32:47], v[84:87], v[72:75], v[32:47]
    v_mfma_f32_32x32x16_bf16 v[48:63], v[72:75], v[88:91], v[48:63]
    s_waitcnt lgkmcnt(0)
    v_mfma_f32_32x32x16_bf16 v[16:31], v[92:95], v[76:79], v[16:31]
    v_mfma_f32_32x32x16_bf16 v[32:47], v[96:99], v[76:79], v[32:47]
    v_mfma_f32_32x32x16_bf16 v[48:63], v[76:79], v[100:103], v[48:63]
    s_waitcnt vmcnt(0)
    s_barrier
    ds_read_b128 v[64:67], v5 offset:0
    ds_read_b128 v[68:71], v6 offset:0
    ds_read_b128 v[72:75], v7 offset:0
    ds_read_b128 v[76:79], v8 offset:0
    ds_read_b64_tr_b16 v[80:81], v9 offset:0
    ds_read_b64_tr_b16 v[82:83], v9 offset:768
    ds_read_b64_tr_b16 v[84:85], v9 offset:56
    ds_read_b64_tr_b16 v[86:87], v9 offset:824
    ds_read_b64_tr_b16 v[88:89], v9 offset:112
    ds_read_b64_tr_b16 v[90:91], v9 offset:880
    s_waitcnt lgkmcnt(6)
    ds_read_b64_tr_b16 v[92:93], v9 offset:3072
    ds_read_b64_tr_b16 v[94:95], v9 offset:3840
    ds_read_b64_tr_b16 v[96:97], v9 offset:3128
    ds_read_b64_tr_b16 v[98:99], v9 offset:3896
    ds_read_b64_tr_b16 v[100:101], v9 offset:3184
    ds_read_b64_tr_b16 v[102:103], v9 offset:3952
    s_waitcnt lgkmcnt(6)
    v_mfma_f32_32x32x16_bf16 v[16:31], v[80:83], v[64:67], v[16:31]
    v_mfma_f32_32x32x16_bf16 v[32:47], v[84:87], v[64:67], v[32:47]
    v_mfma_f32_32x32x16_bf16 v[48:63], v[64:67], v[88:91], v[48:63]
    ds_read_b64_tr_b16 v[80:81], v9 offset:6144
    ds_read_b64_tr_b16 v[82:83], v9 offset:6912
    ds_read_b64_tr_b16 v[84:85], v9 offset:6200
    ds_read_b64_tr_b16 v[86:87], v9 offset:6968
    ds_read_b64_tr_b16 v[88:89], v9 offset:6256
    ds_read_b64_tr_b16 v[90:91], v9 offset:7024
    s_waitcnt lgkmcnt(6)
    v_mfma_f32_32x32x16_bf16 v[16:31], v[92:95], v[68:71], v[16:31]
    v_mfma_f32_32x32x16_bf16 v[32:47], v[96:99], v[68:71], v[32:47]
    v_mfma_f32_32x32x16_bf16 v[48:63], v[68:71], v[100:103], v[48:63]
    ds_read_b64_tr_b16 v[92:93], v9 offset:9216
    ds_read_b64_tr_b16 v[94:95], v9 offset:9984
    ds_read_b64_tr_b16 v[96:97], v9 offset:9272
    ds_read_b64_tr_b16 v[98:99], v9 offset:10040
    ds_read_b64_tr_b16 v[100:101], v9 offset:9328
    ds_read_b64_tr_b16 v[102:103], v9 offset:10096
    s_waitcnt lgkmcnt(6)
    v_mfma_f32_32x32x16_bf16 v[16:31], v[80:83], v[72:75], v[16:31]
    v_mfma_f32_32x32x16_bf16 v[32:47], v[84:87], v[72:75], v[32:47]
    v_mfma_f32_32x32x16_bf16 v[48:63], v[72:75], v[88:91], v[48:63]
    s_waitcnt lgkmcnt(0)
    v_mfma_f32_32x32x16_bf16 v[16:31], v[92:95], v[76:79], v[16:31]
    v_mfma_f32_32x32x16_bf16 v[32:47], v[96:99], v[76:79], v[32:47]
    v_mfma_f32_32x32x16_bf16 v[48:63], v[76:79], v[100:103], v[48:63]
    s_branch L_11
L_10:
    s_waitcnt vmcnt(7)
    s_barrier
    ds_read_b128 v[64:67], v5 offset:0
    ds_read_b128 v[68:71], v6 offset:0
    ds_read_b128 v[72:75], v7 offset:0
    ds_read_b128 v[76:79], v8 offset:0
    ds_read_b64_tr_b16 v[80:81], v9 offset:0
    ds_read_b64_tr_b16 v[82:83], v9 offset:768
    ds_read_b64_tr_b16 v[84:85], v9 offset:56
    ds_read_b64_tr_b16 v[86:87], v9 offset:824
    ds_read_b64_tr_b16 v[88:89], v9 offset:112
    ds_read_b64_tr_b16 v[90:91], v9 offset:880
    s_add_u32 s24, s20, 344064
    s_add_u32 m0, s23, 24576
    s_nop 0
    buffer_load_dwordx4 v4, s[8:11], s24 offen lds
    s_add_u32 m0, s23, 25600
    s_nop 0
    buffer_load_dwordx4 v104, s[8:11], s24 offen lds
    s_add_u32 m0, s23, 26624
    s_nop 0
    buffer_load_dwordx4 v105, s[8:11], s24 offen lds
    s_waitcnt lgkmcnt(6)
    s_add_u32 s24, s19, 256
    s_add_u32 m0, s22, 0
    s_nop 0
    buffer_load_dwordx4 v2, s[4:7], s24 offen lds
    s_add_u32 s24, s19, 7424
    s_add_u32 m0, s22, 1024
    s_nop 0
    buffer_load_dwordx4 v3, s[4:7], s24 offen lds
    s_add_u32 s24, s19, 14592
    s_add_u32 m0, s22, 2048
    s_nop 0
    buffer_load_dwordx4 v2, s[4:7], s24 offen lds
    s_add_u32 s24, s19, 21760
    s_add_u32 m0, s22, 3072
    s_nop 0
    buffer_load_dwordx4 v3, s[4:7], s24 offen lds
    ds_read_b64_tr_b16 v[92:93], v9 offset:3072
    ds_read_b64_tr_b16 v[94:95], v9 offset:3840
    ds_read_b64_tr_b16 v[96:97], v9 offset:3128
    ds_read_b64_tr_b16 v[98:99], v9 offset:3896
    ds_read_b64_tr_b16 v[100:101], v9 offset:3184
    ds_read_b64_tr_b16 v[102:103], v9 offset:3952
    s_waitcnt lgkmcnt(6)
    v_mfma_f32_32x32x16_bf16 v[16:31], v[64:67], v[80:83], 0
    v_mfma_f32_32x32x16_bf16 v[32:47], v[64:67], v[84:87], 0
    v_mfma_f32_32x32x16_bf16 v[48:63], v[64:67], v[88:91], 0
    ds_read_b64_tr_b16 v[80:81], v9 offset:6144
    ds_read_b64_tr_b16 v[82:83], v9 offset:6912
    ds_read_b64_tr_b16 v[84:85], v9 offset:6200
    ds_read_b64_tr_b16 v[86:87], v9 offset:6968
    ds_read_b64_tr_b16 v[88:89], v9 offset:6256
    ds_read_b64_tr_b16 v[90:91], v9 offset:7024
    s_waitcnt lgkmcnt(6)
    v_mfma_f32_32x32x16_bf16 v[16:31], v[68:71], v[92:95], v[16:31]
    v_mfma_f32_32x32x16_bf16 v[32:47], v[68:71], v[96:99], v[32:47]
    v_mfma_f32_32x32x16_bf16 v[48:63], v[68:71], v[100:103], v[48:63]
    ds_read_b64_tr_b16 v[92:93], v9 offset:9216
    ds_read_b64_tr_b16 v[94:95], v9 offset:9984
    ds_read_b64_tr_b16 v[96:97], v9 offset:9272
    ds_read_b64_tr_b16 v[98:99], v9 offset:10040
    ds_read_b64_tr_b16 v[100:101], v9 offset:9328
    ds_read_b64_tr_b16 v[102:103], v9 offset:10096
    s_waitcnt lgkmcnt(6)
    v_mfma_f32_32x32x16_bf16 v[16:31], v[72:75], v[80:83], v[16:31]
    v_mfma_f32_32x32x16_bf16 v[32:47], v[72:75], v[84:87], v[32:47]
    v_mfma_f32_32x32x16_bf16 v[48:63], v[72:75], v[88:91], v[48:63]
    s_waitcnt lgkmcnt(0)
    v_mfma_f32_32x32x16_bf16 v[16:31], v[76:79], v[92:95], v[16:31]
    v_mfma_f32_32x32x16_bf16 v[32:47], v[76:79], v[96:99], v[32:47]
    v_mfma_f32_32x32x16_bf16 v[48:63], v[76:79], v[100:103], v[48:63]
    s_waitcnt vmcnt(7)
    s_barrier
    ds_read_b128 v[64:67], v5 offset:16384
    ds_read_b128 v[68:71], v6 offset:16384
    ds_read_b128 v[72:75], v7 offset:16384
    ds_read_b128 v[76:79], v8 offset:16384
    ds_read_b64_tr_b16 v[80:81], v9 offset:12288
    ds_read_b64_tr_b16 v[82:83], v9 offset:13056
    ds_read_b64_tr_b16 v[84:85], v9 offset:12344
    ds_read_b64_tr_b16 v[86:87], v9 offset:13112
    ds_read_b64_tr_b16 v[88:89], v9 offset:12400
    ds_read_b64_tr_b16 v[90:91], v9 offset:13168
    s_add_u32 s24, s20, 516096
    s_add_u32 m0, s23, 0
    s_nop 0
    buffer_load_dwordx4 v4, s[8:11], s24 offen lds
    s_add_u32 m0, s23, 1024
    s_nop 0
    buffer_load_dwordx4 v104, s[8:11], s24 offen lds
    s_add_u32 m0, s23, 2048
    s_nop 0
    buffer_load_dwordx4 v105, s[8:11], s24 offen lds
    s_waitcnt lgkmcnt(6)
    s_add_u32 s24, s19, 384
    s_add_u32 m0, s22, 16384
    s_nop 0
    buffer_load_dwordx4 v2, s[4:7], s24 offen lds
    s_add_u32 s24, s19, 7552
    s_add_u32 m0, s22, 17408
    s_nop 0
    buffer_load_dwordx4 v3, s[4:7], s24 offen lds
    s_add_u32 s24, s19, 14720
    s_add_u32 m0, s22, 18432
    s_nop 0
    buffer_load_dwordx4 v2, s[4:7], s24 offen lds
    s_add_u32 s24, s19, 21888
    s_add_u32 m0, s22, 19456
    s_nop 0
    buffer_load_dwordx4 v3, s[4:7], s24 offen lds
    ds_read_b64_tr_b16 v[92:93], v9 offset:15360
    ds_read_b64_tr_b16 v[94:95], v9 offset:16128
    ds_read_b64_tr_b16 v[96:97], v9 offset:15416
    ds_read_b64_tr_b16 v[98:99], v9 offset:16184
    ds_read_b64_tr_b16 v[100:101], v9 offset:15472
    ds_read_b64_tr_b16 v[102:103], v9 offset:16240
    s_waitcnt lgkmcnt(6)
    v_mfma_f32_32x32x16_bf16 v[16:31], v[64:67], v[80:83], v[16:31]
    v_mfma_f32_32x32x16_bf16 v[32:47], v[64:67], v[84:87], v[32:47]
    v_mfma_f32_32x32x16_bf16 v[48:63], v[64:67], v[88:91], v[48:63]
    ds_read_b64_tr_b16 v[80:81], v9 offset:18432
    ds_read_b64_tr_b16 v[82:83], v9 offset:19200
    ds_read_b64_tr_b16 v[84:85], v9 offset:18488
    ds_read_b64_tr_b16 v[86:87], v9 offset:19256
    ds_read_b64_tr_b16 v[88:89], v9 offset:18544
    ds_read_b64_tr_b16 v[90:91], v9 offset:19312
    s_waitcnt lgkmcnt(6)
    v_mfma_f32_32x32x16_bf16 v[16:31], v[68:71], v[92:95], v[16:31]
    v_mfma_f32_32x32x16_bf16 v[32:47], v[68:71], v[96:99], v[32:47]
    v_mfma_f32_32x32x16_bf16 v[48:63], v[68:71], v[100:103], v[48:63]
    ds_read_b64_tr_b16 v[92:93], v9 offset:21504
    ds_read_b64_tr_b16 v[94:95], v9 offset:22272
    ds_read_b64_tr_b16 v[96:97], v9 offset:21560
    ds_read_b64_tr_b16 v[98:99], v9 offset:22328
    ds_read_b64_tr_b16 v[100:101], v9 offset:21616
    ds_read_b64_tr_b16 v[102:103], v9 offset:22384
    s_waitcnt lgkmcnt(6)
    v_mfma_f32_32x32x16_bf16 v[16:31], v[72:75], v[80:83], v[16:31]
    v_mfma_f32_32x32x16_bf16 v[32:47], v[72:75], v[84:87], v[32:47]
    v_mfma_f32_32x32x16_bf16 v[48:63], v[72:75], v[88:91], v[48:63]
    s_waitcnt lgkmcnt(0)
    v_mfma_f32_32x32x16_bf16 v[16:31], v[76:79], v[92:95], v[16:31]
    v_mfma_f32_32x32x16_bf16 v[32:47], v[76:79], v[96:99], v[32:47]
    v_mfma_f32_32x32x16_bf16 v[48:63], v[76:79], v[100:103], v[48:63]
    s_waitcnt vmcnt(7)
    s_barrier
    ds_read_b128 v[64:67], v5 offset:0
    ds_read_b128 v[68:71], v6 offset:0
    ds_read_b128 v[72:75], v7 offset:0
    ds_read_b128 v[76:79], v8 offset:0
    ds_read_b64_tr_b16 v[80:81], v9 offset:24576
    ds_read_b64_tr_b16 v[82:83], v9 offset:25344
    ds_read_b64_tr_b16 v[84:85], v9 offset:24632
    ds_read_b64_tr_b16 v[86:87], v9 offset:25400
    ds_read_b64_tr_b16 v[88:89], v9 offset:24688
    ds_read_b64_tr_b16 v[90:91], v9 offset:25456
    s_add_u32 s24, s20, 688128
    s_add_u32 m0, s23, 12288
    s_nop 0
    buffer_load_dwordx4 v4, s[8:11], s24 offen lds
    s_add_u32 m0, s23, 13312
    s_nop 0
    buffer_load_dwordx4 v104, s[8:11], s24 offen lds
    s_add_u32 m0, s23, 14336
    s_nop 0
    buffer_load_dwordx4 v105, s[8:11], s24 offen lds
    s_waitcnt lgkmcnt(6)
    s_add_u32 s24, s19, 512
    s_add_u32 m0, s22, 0
    s_nop 0
    buffer_load_dwordx4 v2, s[4:7], s24 offen lds
    s_add_u32 s24, s19, 7680
    s_add_u32 m0, s22, 1024
    s_nop 0
    buffer_load_dwordx4 v3, s[4:7], s24 offen lds
    s_add_u32 s24, s19, 14848
    s_add_u32 m0, s22, 2048
    s_nop 0
    buffer_load_dwordx4 v2, s[4:7], s24 offen lds
    s_add_u32 s24, s19, 22016
    s_add_u32 m0, s22, 3072
    s_nop 0
    buffer_load_dwordx4 v3, s[4:7], s24 offen lds
    ds_read_b64_tr_b16 v[92:93], v9 offset:27648
    ds_read_b64_tr_b16 v[94:95], v9 offset:28416
    ds_read_b64_tr_b16 v[96:97], v9 offset:27704
    ds_read_b64_tr_b16 v[98:99], v9 offset:28472
    ds_read_b64_tr_b16 v[100:101], v9 offset:27760
    ds_read_b64_tr_b16 v[102:103], v9 offset:28528
    s_waitcnt lgkmcnt(6)
    v_mfma_f32_32x32x16_bf16 v[16:31], v[64:67], v[80:83], v[16:31]
    v_mfma_f32_32x32x16_bf16 v[32:47], v[64:67], v[84:87], v[32:47]
    v_mfma_f32_32x32x16_bf16 v[48:63], v[64:67], v[88:91], v[48:63]
    ds_read_b64_tr_b16 v[80:81], v9 offset:30720
    ds_read_b64_tr_b16 v[82:83], v9 offset:31488
    ds_read_b64_tr_b16 v[84:85], v9 offset:30776
    ds_read_b64_tr_b16 v[86:87], v9 offset:31544
    ds_read_b64_tr_b16 v[88:89], v9 offset:30832
    ds_read_b64_tr_b16 v[90:91], v9 offset:31600
    s_waitcnt lgkmcnt(6)
    v_mfma_f32_32x32x16_bf16 v[16:31], v[68:71], v[92:95], v[16:31]
    v_mfma_f32_32x32x16_bf16 v[32:47], v[68:71], v[96:99], v[32:47]
    v_mfma_f32_32x32x16_bf16 v[48:63], v[68:71], v[100:103], v[48:63]
    ds_read_b64_tr_b16 v[92:93], v9 offset:33792
    ds_read_b64_tr_b16 v[94:95], v9 offset:34560
    ds_read_b64_tr_b16 v[96:97], v9 offset:33848
    ds_read_b64_tr_b16 v[98:99], v9 offset:34616
    ds_read_b64_tr_b16 v[100:101], v9 offset:33904
    ds_read_b64_tr_b16 v[102:103], v9 offset:34672
    s_waitcnt lgkmcnt(6)
    v_mfma_f32_32x32x16_bf16 v[16:31], v[72:75], v[80:83], v[16:31]
    v_mfma_f32_32x32x16_bf16 v[32:47], v[72:75], v[84:87], v[32:47]
    v_mfma_f32_32x32x16_bf16 v[48:63], v[72:75], v[88:91], v[48:63]
    s_waitcnt lgkmcnt(0)
    v_mfma_f32_32x32x16_bf16 v[16:31], v[76:79], v[92:95], v[16:31]
    v_mfma_f32_32x32x16_bf16 v[32:47], v[76:79], v[96:99], v[32:47]
    v_mfma_f32_32x32x16_bf16 v[48:63], v[76:79], v[100:103], v[48:63]
    s_waitcnt vmcnt(7)
    s_barrier
    ds_read_b128 v[64:67], v5 offset:16384
    ds_read_b128 v[68:71], v6 offset:16384
    ds_read_b128 v[72:75], v7 offset:16384
    ds_read_b128 v[76:79], v8 offset:16384
    ds_read_b64_tr_b16 v[80:81], v9 offset:0
    ds_read_b64_tr_b16 v[82:83], v9 offset:768
    ds_read_b64_tr_b16 v[84:85], v9 offset:56
    ds_read_b64_tr_b16 v[86:87], v9 offset:824
    ds_read_b64_tr_b16 v[88:89], v9 offset:112
    ds_read_b64_tr_b16 v[90:91], v9 offset:880
    s_add_u32 s24, s20, 860160
    s_add_u32 m0, s23, 24576
    s_nop 0
    buffer_load_dwordx4 v4, s[8:11], s24 offen lds
    s_add_u32 m0, s23, 25600
    s_nop 0
    buffer_load_dwordx4 v104, s[8:11], s24 offen lds
    s_add_u32 m0, s23, 26624
    s_nop 0
    buffer_load_dwordx4 v105, s[8:11], s24 offen lds
    s_waitcnt lgkmcnt(6)
    s_add_u32 s24, s19, 640
    s_add_u32 m0, s22, 16384
    s_nop 0
    buffer_load_dwordx4 v2, s[4:7], s24 offen lds
    s_add_u32 s24, s19, 7808
    s_add_u32 m0, s22, 17408
    s_nop 0
    buffer_load_dwordx4 v3, s[4:7], s24 offen lds
    s_add_u32 s24, s19, 14976
    s_add_u32 m0, s22, 18432
    s_nop 0
    buffer_load_dwordx4 v2, s[4:7], s24 offen lds
    s_add_u32 s24, s19, 22144
    s_add_u32 m0, s22, 19456
    s_nop 0
    buffer_load_dwordx4 v3, s[4:7], s24 offen lds
    ds_read_b64_tr_b16 v[92:93], v9 offset:3072
    ds_read_b64_tr_b16 v[94:95], v9 offset:3840
    ds_read_b64_tr_b16 v[96:97], v9 offset:3128
    ds_read_b64_tr_b16 v[98:99], v9 offset:3896
    ds_read_b64_tr_b16 v[100:101], v9 offset:3184
    ds_read_b64_tr_b16 v[102:103], v9 offset:3952
    s_waitcnt lgkmcnt(6)
    v_mfma_f32_32x32x16_bf16 v[16:31], v[64:67], v[80:83], v[16:31]
    v_mfma_f32_32x32x16_bf16 v[32:47], v[64:67], v[84:87], v[32:47]
    v_mfma_f32_32x32x16_bf16 v[48:63], v[64:67], v[88:91], v[48:63]
    ds_read_b64_tr_b16 v[80:81], v9 offset:6144
    ds_read_b64_tr_b16 v[82:83], v9 offset:6912
    ds_read_b64_tr_b16 v[84:85], v9 offset:6200
    ds_read_b64_tr_b16 v[86:87], v9 offset:6968
    ds_read_b64_tr_b16 v[88:89], v9 offset:6256
    ds_read_b64_tr_b16 v[90:91], v9 offset:7024
    s_waitcnt lgkmcnt(6)
    v_mfma_f32_32x32x16_bf16 v[16:31], v[68:71], v[92:95], v[16:31]
    v_mfma_f32_32x32x16_bf16 v[32:47], v[68:71], v[96:99], v[32:47]
    v_mfma_f32_32x32x16_bf16 v[48:63], v[68:71], v[100:103], v[48:63]
    ds_read_b64_tr_b16 v[92:93], v9 offset:9216
    ds_read_b64_tr_b16 v[94:95], v9 offset:9984
    ds_read_b64_tr_b16 v[96:97], v9 offset:9272
    ds_read_b64_tr_b16 v[98:99], v9 offset:10040
    ds_read_b64_tr_b16 v[100:101], v9 offset:9328
    ds_read_b64_tr_b16 v[102:103], v9 offset:10096
    s_waitcnt lgkmcnt(6)
    v_mfma_f32_32x32x16_bf16 v[16:31], v[72:75], v[80:83], v[16:31]
    v_mfma_f32_32x32x16_bf16 v[32:47], v[72:75], v[84:87], v[32:47]
    v_mfma_f32_32x32x16_bf16 v[48:63], v[72:75], v[88:91], v[48:63]
    s_waitcnt lgkmcnt(0)
    v_mfma_f32_32x32x16_bf16 v[16:31], v[76:79], v[92:95], v[16:31]
    v_mfma_f32_32x32x16_bf16 v[32:47], v[76:79], v[96:99], v[32:47]
    v_mfma_f32_32x32x16_bf16 v[48:63], v[76:79], v[100:103], v[48:63]
    s_waitcnt vmcnt(7)
    s_barrier
    ds_read_b128 v[64:67], v5 offset:0
    ds_read_b128 v[68:71], v6 offset:0
    ds_read_b128 v[72:75], v7 offset:0
    ds_read_b128 v[76:79], v8 offset:0
    ds_read_b64_tr_b16 v[80:81], v9 offset:12288
    ds_read_b64_tr_b16 v[82:83], v9 offset:13056
    ds_read_b64_tr_b16 v[84:85], v9 offset:12344
    ds_read_b64_tr_b16 v[86:87], v9 offset:13112
    ds_read_b64_tr_b16 v[88:89], v9 offset:12400
    ds_read_b64_tr_b16 v[90:91], v9 offset:13168
    s_add_u32 s24, s20, 1032192
    s_add_u32 m0, s23, 0
    s_nop 0
    buffer_load_dwordx4 v4, s[8:11], s24 offen lds
    s_add_u32 m0, s23, 1024
    s_nop 0
    buffer_load_dwordx4 v104, s[8:11], s24 offen lds
    s_add_u32 m0, s23, 2048
    s_nop 0
    buffer_load_dwordx4 v105, s[8:11], s24 offen lds
    s_waitcnt lgkmcnt(6)
    s_add_u32 s24, s19, 768
    s_add_u32 m0, s22, 0
    s_nop 0
    buffer_load_dwordx4 v2, s[4:7], s24 offen lds
    s_add_u32 s24, s19, 7936
    s_add_u32 m0, s22, 1024
    s_nop 0
    buffer_load_dwordx4 v3, s[4:7], s24 offen lds
    s_add_u32 s24, s19, 15104
    s_add_u32 m0, s22, 2048
    s_nop 0
    buffer_load_dwordx4 v2, s[4:7], s24 offen lds
    s_add_u32 s24, s19, 22272
    s_add_u32 m0, s22, 3072
    s_nop 0
    buffer_load_dwordx4 v3, s[4:7], s24 offen lds
    ds_read_b64_tr_b16 v[92:93], v9 offset:15360
    ds_read_b64_tr_b16 v[94:95], v9 offset:16128
    ds_read_b64_tr_b16 v[96:97], v9 offset:15416
    ds_read_b64_tr_b16 v[98:99], v9 offset:16184
    ds_read_b64_tr_b16 v[100:101], v9 offset:15472
    ds_read_b64_tr_b16 v[102:103], v9 offset:16240
    s_waitcnt lgkmcnt(6)
    v_mfma_f32_32x32x16_bf16 v[16:31], v[64:67], v[80:83], v[16:31]
    v_mfma_f32_32x32x16_bf16 v[32:47], v[64:67], v[84:87], v[32:47]
    v_mfma_f32_32x32x16_bf16 v[48:63], v[64:67], v[88:91], v[48:63]
    ds_read_b64_tr_b16 v[80:81], v9 offset:18432
    ds_read_b64_tr_b16 v[82:83], v9 offset:19200
    ds_read_b64_tr_b16 v[84:85], v9 offset:18488
    ds_read_b64_tr_b16 v[86:87], v9 offset:19256
    ds_read_b64_tr_b16 v[88:89], v9 offset:18544
    ds_read_b64_tr_b16 v[90:91], v9 offset:19312
    s_waitcnt lgkmcnt(6)
    v_mfma_f32_32x32x16_bf16 v[16:31], v[68:71], v[92:95], v[16:31]
    v_mfma_f32_32x32x16_bf16 v[32:47], v[68:71], v[96:99], v[32:47]
    v_mfma_f32_32x32x16_bf16 v[48:63], v[68:71], v[100:103], v[48:63]
    ds_read_b64_tr_b16 v[92:93], v9 offset:21504
    ds_read_b64_tr_b16 v[94:95], v9 offset:22272
    ds_read_b64_tr_b16 v[96:97], v9 offset:21560
    ds_read_b64_tr_b16 v[98:99], v9 offset:22328
    ds_read_b64_tr_b16 v[100:101], v9 offset:21616
    ds_read_b64_tr_b16 v[102:103], v9 offset:22384
    s_waitcnt lgkmcnt(6)
    v_mfma_f32_32x32x16_bf16 v[16:31], v[72:75], v[80:83], v[16:31]
    v_mfma_f32_32x32x16_bf16 v[32:47], v[72:75], v[84:87], v[32:47]
    v_mfma_f32_32x32x16_bf16 v[48:63], v[72:75], v[88:91], v[48:63]
    s_waitcnt lgkmcnt(0)
    v_mfma_f32_32x32x16_bf16 v[16:31], v[76:79], v[92:95], v[16:31]
    v_mfma_f32_32x32x16_bf16 v[32:47], v[76:79], v[96:99], v[32:47]
    v_mfma_f32_32x32x16_bf16 v[48:63], v[76:79], v[100:103], v[48:63]
    s_waitcnt vmcnt(7)
    s_barrier
    ds_read_b128 v[64:67], v5 offset:16384
    ds_read_b128 v[68:71], v6 offset:16384
    ds_read_b128 v[72:75], v7 offset:16384
    ds_read_b128 v[76:79], v8 offset:16384
    ds_read_b64_tr_b16 v[80:81], v9 offset:24576
    ds_read_b64_tr_b16 v[82:83], v9 offset:25344
    ds_read_b64_tr_b16 v[84:85], v9 offset:24632
    ds_read_b64_tr_b16 v[86:87], v9 offset:25400
    ds_read_b64_tr_b16 v[88:89], v9 offset:24688
    ds_read_b64_tr_b16 v[90:91], v9 offset:25456
    s_waitcnt lgkmcnt(6)
    ds_read_b64_tr_b16 v[92:93], v9 offset:27648
    ds_read_b64_tr_b16 v[94:95], v9 offset:28416
    ds_read_b64_tr_b16 v[96:97], v9 offset:27704
    ds_read_b64_tr_b16 v[98:99], v9 offset:28472
    ds_read_b64_tr_b16 v[100:101], v9 offset:27760
    ds_read_b64_tr_b16 v[102:103], v9 offset:28528
    s_waitcnt lgkmcnt(6)
    v_mfma_f32_32x32x16_bf16 v[16:31], v[64:67], v[80:83], v[16:31]
    v_mfma_f32_32x32x16_bf16 v[32:47], v[64:67], v[84:87], v[32:47]
    v_mfma_f32_32x32x16_bf16 v[48:63], v[64:67], v[88:91], v[48:63]
    ds_read_b64_tr_b16 v[80:81], v9 offset:30720
    ds_read_b64_tr_b16 v[82:83], v9 offset:31488
    ds_read_b64_tr_b16 v[84:85], v9 offset:30776
    ds_read_b64_tr_b16 v[86:87], v9 offset:31544
    ds_read_b64_tr_b16 v[88:89], v9 offset:30832
    ds_read_b64_tr_b16 v[90:91], v9 offset:31600
    s_waitcnt lgkmcnt(6)
    v_mfma_f32_32x32x16_bf16 v[16:31], v[68:71], v[92:95], v[16:31]
    v_mfma_f32_32x32x16_bf16 v[32:47], v[68:71], v[96:99], v[32:47]
    v_mfma_f32_32x32x16_bf16 v[48:63], v[68:71], v[100:103], v[48:63]
    ds_read_b64_tr_b16 v[92:93], v9 offset:33792
    ds_read_b64_tr_b16 v[94:95], v9 offset:34560
    ds_read_b64_tr_b16 v[96:97], v9 offset:33848
    ds_read_b64_tr_b16 v[98:99], v9 offset:34616
    ds_read_b64_tr_b16 v[100:101], v9 offset:33904
    ds_read_b64_tr_b16 v[102:103], v9 offset:34672
    s_waitcnt lgkmcnt(6)
    v_mfma_f32_32x32x16_bf16 v[16:31], v[72:75], v[80:83], v[16:31]
    v_mfma_f32_32x32x16_bf16 v[32:47], v[72:75], v[84:87], v[32:47]
    v_mfma_f32_32x32x16_bf16 v[48:63], v[72:75], v[88:91], v[48:63]
    s_waitcnt lgkmcnt(0)
    v_mfma_f32_32x32x16_bf16 v[16:31], v[76:79], v[92:95], v[16:31]
    v_mfma_f32_32x32x16_bf16 v[32:47], v[76:79], v[96:99], v[32:47]
    v_mfma_f32_32x32x16_bf16 v[48:63], v[76:79], v[100:103], v[48:63]
    s_waitcnt vmcnt(0)
    s_barrier
    ds_read_b128 v[64:67], v5 offset:0
    ds_read_b128 v[68:71], v6 offset:0
    ds_read_b128 v[72:75], v7 offset:0
    ds_read_b128 v[76:79], v8 offset:0
    ds_read_b64_tr_b16 v[80:81], v9 offset:0
    ds_read_b64_tr_b16 v[82:83], v9 offset:768
    ds_read_b64_tr_b16 v[84:85], v9 offset:56
    ds_read_b64_tr_b16 v[86:87], v9 offset:824
    ds_read_b64_tr_b16 v[88:89], v9 offset:112
    ds_read_b64_tr_b16 v[90:91], v9 offset:880
    s_waitcnt lgkmcnt(6)
    ds_read_b64_tr_b16 v[92:93], v9 offset:3072
    ds_read_b64_tr_b16 v[94:95], v9 offset:3840
    ds_read_b64_tr_b16 v[96:97], v9 offset:3128
    ds_read_b64_tr_b16 v[98:99], v9 offset:3896
    ds_read_b64_tr_b16 v[100:101], v9 offset:3184
    ds_read_b64_tr_b16 v[102:103], v9 offset:3952
    s_waitcnt lgkmcnt(6)
    v_mfma_f32_32x32x16_bf16 v[16:31], v[64:67], v[80:83], v[16:31]
    v_mfma_f32_32x32x16_bf16 v[32:47], v[64:67], v[84:87], v[32:47]
    v_mfma_f32_32x32x16_bf16 v[48:63], v[64:67], v[88:91], v[48:63]
    ds_read_b64_tr_b16 v[80:81], v9 offset:6144
    ds_read_b64_tr_b16 v[82:83], v9 offset:6912
    ds_read_b64_tr_b16 v[84:85], v9 offset:6200
    ds_read_b64_tr_b16 v[86:87], v9 offset:6968
    ds_read_b64_tr_b16 v[88:89], v9 offset:6256
    ds_read_b64_tr_b16 v[90:91], v9 offset:7024
    s_waitcnt lgkmcnt(6)
    v_mfma_f32_32x32x16_bf16 v[16:31], v[68:71], v[92:95], v[16:31]
    v_mfma_f32_32x32x16_bf16 v[32:47], v[68:71], v[96:99], v[32:47]
    v_mfma_f32_32x32x16_bf16 v[48:63], v[68:71], v[100:103], v[48:63]
    ds_read_b64_tr_b16 v[92:93], v9 offset:9216
    ds_read_b64_tr_b16 v[94:95], v9 offset:9984
    ds_read_b64_tr_b16 v[96:97], v9 offset:9272
    ds_read_b64_tr_b16 v[98:99], v9 offset:10040
    ds_read_b64_tr_b16 v[100:101], v9 offset:9328
    ds_read_b64_tr_b16 v[102:103], v9 offset:10096
    s_waitcnt lgkmcnt(6)
    v_mfma_f32_32x32x16_bf16 v[16:31], v[72:75], v[80:83], v[16:31]
    v_mfma_f32_32x32x16_bf16 v[32:47], v[72:75], v[84:87], v[32:47]
    v_mfma_f32_32x32x16_bf16 v[48:63], v[72:75], v[88:91], v[48:63]
    s_waitcnt lgkmcnt(0)
    v_mfma_f32_32x32x16_bf16 v[16:31], v[76:79], v[92:95], v[16:31]
    v_mfma_f32_32x32x16_bf16 v[32:47], v[76:79], v[96:99], v[32:47]
    v_mfma_f32_32x32x16_bf16 v[48:63], v[76:79], v[100:103], v[48:63]
L_11:
    s_mov_b32 s25, 0x3e8b97f6
    s_lshl_b32 s3, s16, 2
    s_add_u32 s3, s3, s18
    s_lshl_b32 s3, s3, 11
    s_mul_i32 s30, s17, 3
    s_lshl_b32 s24, s30, 17
    s_add_u32 s3, s3, s24
    v_lshlrev_b32 v1, 4, v0
    v_cmp_gt_u32 s[26:27], v0, 31
    v_and_b32 v10, 31, v0
    v_cmp_gt_u32 s[28:29], v10, 27
    v_cmp_eq_u32 vcc, 28, v10
    v_mov_b32 v11, 0x3f803f80
    v_mov_b32 v12, 0x3f80
    v_mov_b32 v13, 0
    v_cndmask_b32 v14, 0, v11, vcc
    s_nop 7
    s_add_u32 s31, s30, 0
    s_cmp_ge_u32 s31, 32
    s_cbranch_scc1 L_13
    s_cmp_ge_u32 s31, 16
    s_cbranch_scc1 L_12
    v_mul_f32 v16, s25, v16
    v_mul_f32 v17, s25, v17
    v_mul_f32 v18, s25, v18
    v_mul_f32 v19, s25, v19
    v_mul_f32 v20, s25, v20
    v_mul_f32 v21, s25, v21
    v_mul_f32 v22, s25, v22
    v_mul_f32 v23, s25, v23
    v_mul_f32 v24, s25, v24
    v_mul_f32 v25, s25, v25
    v_mul_f32 v26, s25, v26
    v_mul_f32 v27, s25, v27
    v_mul_f32 v28, s25, v28
    v_mul_f32 v29, s25, v29
    v_mul_f32 v30, s25, v30
    v_mul_f32 v31, s25, v31
    v_cvt_pk_bf16_f32 v64, v16, v17
    v_cvt_pk_bf16_f32 v65, v18, v19
    v_cvt_pk_bf16_f32 v66, v20, v21
    v_cvt_pk_bf16_f32 v67, v22, v23
    v_cvt_pk_bf16_f32 v68, v24, v25
    v_cvt_pk_bf16_f32 v69, v26, v27
    v_cvt_pk_bf16_f32 v70, v28, v29
    v_cvt_pk_bf16_f32 v71, v30, v31
    v_cndmask_b32 v70, v70, v13, s[26:27]
    v_cndmask_b32 v71, v71, v13, s[26:27]
    s_branch L_14
L_12:
    v_cvt_pk_bf16_f32 v64, v16, v17
    v_cvt_pk_bf16_f32 v65, v18, v19
    v_cvt_pk_bf16_f32 v66, v20, v21
    v_cvt_pk_bf16_f32 v67, v22, v23
    v_cvt_pk_bf16_f32 v68, v24, v25
    v_cvt_pk_bf16_f32 v69, v26, v27
    v_cvt_pk_bf16_f32 v70, v28, v29
    v_cvt_pk_bf16_f32 v71, v30, v31
    v_cndmask_b32 v70, v70, v11, s[26:27]
    v_cndmask_b32 v71, v71, v12, s[26:27]
    s_branch L_14
L_13:
    v_cvt_pk_bf16_f32 v64, v16, v17
    v_cvt_pk_bf16_f32 v65, v18, v19
    v_cvt_pk_bf16_f32 v66, v20, v21
    v_cvt_pk_bf16_f32 v67, v22, v23
    v_cvt_pk_bf16_f32 v68, v24, v25
    v_cvt_pk_bf16_f32 v69, v26, v27
    v_cvt_pk_bf16_f32 v70, v28, v29
    v_cvt_pk_bf16_f32 v71, v30, v31
    v_cndmask_b32 v64, v64, v14, s[28:29]
    v_cndmask_b32 v65, v65, v14, s[28:29]
    v_cndmask_b32 v66, v66, v14, s[28:29]
    v_cndmask_b32 v67, v67, v14, s[28:29]
    v_cndmask_b32 v68, v68, v14, s[28:29]
    v_cndmask_b32 v69, v69, v14, s[28:29]
    v_cndmask_b32 v70, v70, v14, s[28:29]
    v_cndmask_b32 v71, v71, v14, s[28:29]
L_14:
    s_add_u32 s24, s3, 0
    buffer_store_dwordx4 v[64:67], v1, s[12:15], s24 offen sc1
    buffer_store_dwordx4 v[68:71], v1, s[12:15], s24 offen offset:1024 sc1
    s_add_u32 s31, s30, 1
    s_cmp_ge_u32 s31, 32
    s_cbranch_scc1 L_16
    s_cmp_ge_u32 s31, 16
    s_cbranch_scc1 L_15
    v_mul_f32 v32, s25, v32
    v_mul_f32 v33, s25, v33
    v_mul_f32 v34, s25, v34
    v_mul_f32 v35, s25, v35
    v_mul_f32 v36, s25, v36
    v_mul_f32 v37, s25, v37
    v_mul_f32 v38, s25, v38
    v_mul_f32 v39, s25, v39
    v_mul_f32 v40, s25, v40
    v_mul_f32 v41, s25, v41
    v_mul_f32 v42, s25, v42
    v_mul_f32 v43, s25, v43
    v_mul_f32 v44, s25, v44
    v_mul_f32 v45, s25, v45
    v_mul_f32 v46, s25, v46
    v_mul_f32 v47, s25, v47
    v_cvt_pk_bf16_f32 v72, v32, v33
    v_cvt_pk_bf16_f32 v73, v34, v35
    v_cvt_pk_bf16_f32 v74, v36, v37
    v_cvt_pk_bf16_f32 v75, v38, v39
    v_cvt_pk_bf16_f32 v76, v40, v41
    v_cvt_pk_bf16_f32 v77, v42, v43
    v_cvt_pk_bf16_f32 v78, v44, v45
    v_cvt_pk_bf16_f32 v79, v46, v47
    v_cndmask_b32 v78, v78, v13, s[26:27]
    v_cndmask_b32 v79, v79, v13, s[26:27]
    s_branch L_17
L_15:
    v_cvt_pk_bf16_f32 v72, v32, v33
    v_cvt_pk_bf16_f32 v73, v34, v35
    v_cvt_pk_bf16_f32 v74, v36, v37
    v_cvt_pk_bf16_f32 v75, v38, v39
    v_cvt_pk_bf16_f32 v76, v40, v41
    v_cvt_pk_bf16_f32 v77, v42, v43
    v_cvt_pk_bf16_f32 v78, v44, v45
    v_cvt_pk_bf16_f32 v79, v46, v47
    v_cndmask_b32 v78, v78, v11, s[26:27]
    v_cndmask_b32 v79, v79, v12, s[26:27]
    s_branch L_17
L_16:
    v_cvt_pk_bf16_f32 v72, v32, v33
    v_cvt_pk_bf16_f32 v73, v34, v35
    v_cvt_pk_bf16_f32 v74, v36, v37
    v_cvt_pk_bf16_f32 v75, v38, v39
    v_cvt_pk_bf16_f32 v76, v40, v41
    v_cvt_pk_bf16_f32 v77, v42, v43
    v_cvt_pk_bf16_f32 v78, v44, v45
    v_cvt_pk_bf16_f32 v79, v46, v47
    v_cndmask_b32 v72, v72, v14, s[28:29]
    v_cndmask_b32 v73, v73, v14, s[28:29]
    v_cndmask_b32 v74, v74, v14, s[28:29]
    v_cndmask_b32 v75, v75, v14, s[28:29]
    v_cndmask_b32 v76, v76, v14, s[28:29]
    v_cndmask_b32 v77, v77, v14, s[28:29]
    v_cndmask_b32 v78, v78, v14, s[28:29]
    v_cndmask_b32 v79, v79, v14, s[28:29]
L_17:
    s_add_u32 s24, s3, 131072
    buffer_store_dwordx4 v[72:75], v1, s[12:15], s24 offen sc1
    buffer_store_dwordx4 v[76:79], v1, s[12:15], s24 offen offset:1024 sc1
    s_add_u32 s31, s30, 2
    s_cmp_ge_u32 s31, 32
    s_cbranch_scc1 L_19
    s_cmp_ge_u32 s31, 16
    s_cbranch_scc1 L_18
    v_mul_f32 v48, s25, v48
    v_mul_f32 v49, s25, v49
    v_mul_f32 v50, s25, v50
    v_mul_f32 v51, s25, v51
    v_mul_f32 v52, s25, v52
    v_mul_f32 v53, s25, v53
    v_mul_f32 v54, s25, v54
    v_mul_f32 v55, s25, v55
    v_mul_f32 v56, s25, v56
    v_mul_f32 v57, s25, v57
    v_mul_f32 v58, s25, v58
    v_mul_f32 v59, s25, v59
    v_mul_f32 v60, s25, v60
    v_mul_f32 v61, s25, v61
    v_mul_f32 v62, s25, v62
    v_mul_f32 v63, s25, v63
    v_cvt_pk_bf16_f32 v80, v48, v49
    v_cvt_pk_bf16_f32 v81, v50, v51
    v_cvt_pk_bf16_f32 v82, v52, v53
    v_cvt_pk_bf16_f32 v83, v54, v55
    v_cvt_pk_bf16_f32 v84, v56, v57
    v_cvt_pk_bf16_f32 v85, v58, v59
    v_cvt_pk_bf16_f32 v86, v60, v61
    v_cvt_pk_bf16_f32 v87, v62, v63
    v_cndmask_b32 v86, v86, v13, s[26:27]
    v_cndmask_b32 v87, v87, v13, s[26:27]
    s_branch L_20
L_18:
    v_cvt_pk_bf16_f32 v80, v48, v49
    v_cvt_pk_bf16_f32 v81, v50, v51
    v_cvt_pk_bf16_f32 v82, v52, v53
    v_cvt_pk_bf16_f32 v83, v54, v55
    v_cvt_pk_bf16_f32 v84, v56, v57
    v_cvt_pk_bf16_f32 v85, v58, v59
    v_cvt_pk_bf16_f32 v86, v60, v61
    v_cvt_pk_bf16_f32 v87, v62, v63
    v_cndmask_b32 v86, v86, v11, s[26:27]
    v_cndmask_b32 v87, v87, v12, s[26:27]
    s_branch L_20
L_19:
    v_cvt_pk_bf16_f32 v80, v48, v49
    v_cvt_pk_bf16_f32 v81, v50, v51
    v_cvt_pk_bf16_f32 v82, v52, v53
    v_cvt_pk_bf16_f32 v83, v54, v55
    v_cvt_pk_bf16_f32 v84, v56, v57
    v_cvt_pk_bf16_f32 v85, v58, v59
    v_cvt_pk_bf16_f32 v86, v60, v61
    v_cvt_pk_bf16_f32 v87, v62, v63
    v_cndmask_b32 v80, v80, v14, s[28:29]
    v_cndmask_b32 v81, v81, v14, s[28:29]
    v_cndmask_b32 v82, v82, v14, s[28:29]
    v_cndmask_b32 v83, v83, v14, s[28:29]
    v_cndmask_b32 v84, v84, v14, s[28:29]
    v_cndmask_b32 v85, v85, v14, s[28:29]
    v_cndmask_b32 v86, v86, v14, s[28:29]
    v_cndmask_b32 v87, v87, v14, s[28:29]
L_20:
    s_add_u32 s24, s3, 262144
    buffer_store_dwordx4 v[80:83], v1, s[12:15], s24 offen sc1
    buffer_store_dwordx4 v[84:87], v1, s[12:15], s24 offen offset:1024 sc1
    s_endpgm
R_3:
    s_sub_u32 s2, s2, 480
    s_load_dwordx2 s[4:5], s[0:1], 0
    s_load_dwordx2 s[8:9], s[0:1], 80
    s_load_dwordx2 s[12:13], s[0:1], 104
    s_load_dwordx2 s[16:17], s[0:1], 72
    v_lshrrev_b32 v1, 6, v0
    v_and_b32 v0, 63, v0
    v_readfirstlane_b32 s20, v1
    s_waitcnt lgkmcnt(0)
    s_mov_b32 s6, 0x1c0000
    s_mov_b32 s7, 0x20000
    s_mov_b32 s10, 0x380
    s_mov_b32 s11, 0x20000
    s_mov_b32 s14, 0x1000000
    s_mov_b32 s15, 0x20000
    s_mov_b32 s18, 0x62000
    s_mov_b32 s19, 0x20000
    v_lshrrev_b32 v2, 3, v0
    v_mul_u32_u24 v2, 896, v2
    v_and_b32 v3, 7, v0
    v_lshlrev_b32 v3, 4, v3
    v_add_u32 v2, v2, v3
    s_and_b32 s3, s2, 3
    s_lshl_b32 s3, s3, 3
    s_and_b32 s21, s2, 4
    s_or_b32 s3, s3, s21
    s_bfe_u32 s21, s2, 0x20003
    s_or_b32 s3, s3, s21
    s_lshl_b32 s3, s3, 2
    s_add_u32 s3, s3, s20
    s_mul_i32 s21, s3, 16*896
    s_add_u32 s22, s21, 8*896
    buffer_load_dwordx4 v[16:19], v2, s[4:7], s21 offen offset:0
    buffer_load_dwordx4 v[80:83], v3, s[8:11], 0 offen offset:0
    buffer_load_dwordx4 v[44:47], v2, s[4:7], s22 offen offset:0
    buffer_load_dwordx4 v[20:23], v2, s[4:7], s21 offen offset:128
    buffer_load_dwordx4 v[84:87], v3, s[8:11], 0 offen offset:128
    buffer_load_dwordx4 v[48:51], v2, s[4:7], s22 offen offset:128
    buffer_load_dwordx4 v[24:27], v2, s[4:7], s21 offen offset:256
    buffer_load_dwordx4 v[88:91], v3, s[8:11], 0 offen offset:256
    buffer_load_dwordx4 v[52:55], v2, s[4:7], s22 offen offset:256
    buffer_load_dwordx4 v[28:31], v2, s[4:7], s21 offen offset:384
    buffer_load_dwordx4 v[92:95], v3, s[8:11], 0 offen offset:384
    buffer_load_dwordx4 v[56:59], v2, s[4:7], s22 offen offset:384
    buffer_load_dwordx4 v[32:35], v2, s[4:7], s21 offen offset:512
    buffer_load_dwordx4 v[96:99], v3, s[8:11], 0 offen offset:512
    buffer_load_dwordx4 v[60:63], v2, s[4:7], s22 offen offset:512
    buffer_load_dwordx4 v[36:39], v2, s[4:7], s21 offen offset:640
    buffer_load_dwordx4 v[100:103], v3, s[8:11], 0 offen offset:640
    buffer_load_dwordx4 v[64:67], v2, s[4:7], s22 offen offset:640
    buffer_load_dwordx4 v[40:43], v2, s[4:7], s21 offen offset:768
    buffer_load_dwordx4 v[104:107], v3, s[8:11], 0 offen offset:768
    buffer_load_dwordx4 v[68:71], v2, s[4:7], s22 offen offset:768
    v_lshrrev_b32 v5, 5, v0
    v_and_b32 v6, 31, v0
    v_lshlrev_b32 v6, 1, v6
    v_mul_u32_u24 v5, 4*896, v5
    v_add_u32 v5, v5, v6
    v_cmp_gt_u32 vcc, v0, 31
    v_mov_b32 v7, 0x40000000
    v_add_u32 v144, 0, v5
    v_add_u32 v145, 896, v5
    v_add_u32 v146, 1792, v5
    v_add_u32 v147, 2688, v5
    v_add_u32 v148, 7168, v5
    v_add_u32 v149, 8064, v5
    v_add_u32 v150, 8960, v5
    v_add_u32 v151, 9856, v5
    v_add_u32 v152, 14336, v5
    v_add_u32 v153, 15232, v5
    v_add_u32 v154, 16128, v5
    v_add_u32 v155, 17024, v5
    v_add_u32 v156, 21504, v5
    v_cndmask_b32 v156, v156, v7, vcc
    v_add_u32 v157, 22400, v5
    v_cndmask_b32 v157, v157, v7, vcc
    v_add_u32 v158, 23296, v5
    v_cndmask_b32 v158, v158, v7, vcc
    v_add_u32 v159, 24192, v5
    v_cndmask_b32 v159, v159, v7, vcc
    v_lshlrev_b32 v8, 4, v0
    s_and_b32 s22, s20, 1
    s_cmp_eq_u32 s22, 0
    s_cbranch_scc1 L_21
    v_mov_b32 v144, v152
    v_mov_b32 v145, v153
    v_mov_b32 v146, v154
    v_mov_b32 v147, v155
    v_mov_b32 v148, v156
    v_mov_b32 v149, v157
    v_mov_b32 v150, v158
    v_mov_b32 v151, v159
L_21:
    s_mul_i32 s23, s2, 14
    s_add_u32 s23, s23, s20
    s_add_u32 s23, s23, 0
    s_lshr_b32 s24, s23, 1
    s_and_b32 s25, s24, 15
    s_lshr_b32 s24, s24, 4
    s_mul_i32 s25, s25, 28*896
    s_lshl_b32 s24, s24, 6
    s_add_u32 s25, s25, s24
    s_lshl_b32 s23, s23, 10
    s_add_u32 s26, s23, 8388608
    buffer_load_ushort v160, v144, s[16:19], s25 offen
    buffer_load_ushort v161, v145, s[16:19], s25 offen
    buffer_load_ushort v162, v146, s[16:19], s25 offen
    buffer_load_ushort v163, v147, s[16:19], s25 offen
    buffer_load_ushort v164, v148, s[16:19], s25 offen
    buffer_load_ushort v165, v149, s[16:19], s25 offen
    buffer_load_ushort v166, v150, s[16:19], s25 offen
    buffer_load_ushort v167, v151, s[16:19], s25 offen
L_22:
    s_mul_i32 s23, s2, 14
    s_add_u32 s23, s23, s20
    s_add_u32 s23, s23, 4
    s_lshr_b32 s24, s23, 1
    s_and_b32 s25, s24, 15
    s_lshr_b32 s24, s24, 4
    s_mul_i32 s25, s25, 28*896
    s_lshl_b32 s24, s24, 6
    s_add_u32 s25, s25, s24
    s_lshl_b32 s23, s23, 10
    s_add_u32 s27, s23, 8388608
    buffer_load_ushort v168, v144, s[16:19], s25 offen
    buffer_load_ushort v169, v145, s[16:19], s25 offen
    buffer_load_ushort v170, v146, s[16:19], s25 offen
    buffer_load_ushort v171, v147, s[16:19], s25 offen
    buffer_load_ushort v172, v148, s[16:19], s25 offen
    buffer_load_ushort v173, v149, s[16:19], s25 offen
    buffer_load_ushort v174, v150, s[16:19], s25 offen
    buffer_load_ushort v175, v151, s[16:19], s25 offen
L_23:
    s_mul_i32 s23, s2, 14
    s_add_u32 s23, s23, s20
    s_add_u32 s23, s23, 8
    s_lshr_b32 s24, s23, 1
    s_and_b32 s25, s24, 15
    s_lshr_b32 s24, s24, 4
    s_mul_i32 s25, s25, 28*896
    s_lshl_b32 s24, s24, 6
    s_add_u32 s25, s25, s24
    s_lshl_b32 s23, s23, 10
    s_add_u32 s28, s23, 8388608
    buffer_load_ushort v176, v144, s[16:19], s25 offen
    buffer_load_ushort v177, v145, s[16:19], s25 offen
    buffer_load_ushort v178, v146, s[16:19], s25 offen
    buffer_load_ushort v179, v147, s[16:19], s25 offen
    buffer_load_ushort v180, v148, s[16:19], s25 offen
    buffer_load_ushort v181, v149, s[16:19], s25 offen
    buffer_load_ushort v182, v150, s[16:19], s25 offen
    buffer_load_ushort v183, v151, s[16:19], s25 offen
L_24:
    s_cmp_ge_u32 s20, 2
    s_cbranch_scc1 L_25
    s_mul_i32 s23, s2, 14
    s_add_u32 s23, s23, s20
    s_add_u32 s23, s23, 12
    s_lshr_b32 s24, s23, 1
    s_and_b32 s25, s24, 15
    s_lshr_b32 s24, s24, 4
    s_mul_i32 s25, s25, 28*896
    s_lshl_b32 s24, s24, 6
    s_add_u32 s25, s25, s24
    s_lshl_b32 s23, s23, 10
    s_add_u32 s29, s23, 8388608
    buffer_load_ushort v184, v144, s[16:19], s25 offen
    buffer_load_ushort v185, v145, s[16:19], s25 offen
    buffer_load_ushort v186, v146, s[16:19], s25 offen
    buffer_load_ushort v187, v147, s[16:19], s25 offen
    buffer_load_ushort v188, v148, s[16:19], s25 offen
    buffer_load_ushort v189, v149, s[16:19], s25 offen
    buffer_load_ushort v190, v150, s[16:19], s25 offen
    buffer_load_ushort v191, v151, s[16:19], s25 offen
L_25:
    v_mov_b32 v9, 0
    v_mov_b32 v10, 0
    v_and_b32 v11, 1, v0
    v_cmp_eq_u32 s[30:31], 1, v11
    s_waitcnt vmcnt(24)
    v_dot2_f32_bf16 v9, v16, v80, v9
    v_dot2_f32_bf16 v10, v44, v80, v10
    v_dot2_f32_bf16 v9, v17, v81, v9
    v_dot2_f32_bf16 v10, v45, v81, v10
    v_dot2_f32_bf16 v9, v18, v82, v9
    v_dot2_f32_bf16 v10, v46, v82, v10
    v_dot2_f32_bf16 v9, v19, v83, v9
    v_dot2_f32_bf16 v10, v47, v83, v10
    v_dot2_f32_bf16 v9, v20, v84, v9
    v_dot2_f32_bf16 v10, v48, v84, v10
    v_dot2_f32_bf16 v9, v21, v85, v9
    v_dot2_f32_bf16 v10, v49, v85, v10
    v_dot2_f32_bf16 v9, v22, v86, v9
    v_dot2_f32_bf16 v10, v50, v86, v10
    v_dot2_f32_bf16 v9, v23, v87, v9
    v_dot2_f32_bf16 v10, v51, v87, v10
    v_dot2_f32_bf16 v9, v24, v88, v9
    v_dot2_f32_bf16 v10, v52, v88, v10
    v_dot2_f32_bf16 v9, v25, v89, v9
    v_dot2_f32_bf16 v10, v53, v89, v10
    v_dot2_f32_bf16 v9, v26, v90, v9
    v_dot2_f32_bf16 v10, v54, v90, v10
    v_dot2_f32_bf16 v9, v27, v91, v9
    v_dot2_f32_bf16 v10, v55, v91, v10
    v_dot2_f32_bf16 v9, v28, v92, v9
    v_dot2_f32_bf16 v10, v56, v92, v10
    v_dot2_f32_bf16 v9, v29, v93, v9
    v_dot2_f32_bf16 v10, v57, v93, v10
    v_dot2_f32_bf16 v9, v30, v94, v9
    v_dot2_f32_bf16 v10, v58, v94, v10
    v_dot2_f32_bf16 v9, v31, v95, v9
    v_dot2_f32_bf16 v10, v59, v95, v10
    v_dot2_f32_bf16 v9, v32, v96, v9
    v_dot2_f32_bf16 v10, v60, v96, v10
    v_dot2_f32_bf16 v9, v33, v97, v9
    v_dot2_f32_bf16 v10, v61, v97, v10
    v_dot2_f32_bf16 v9, v34, v98, v9
    v_dot2_f32_bf16 v10, v62, v98, v10
    v_dot2_f32_bf16 v9, v35, v99, v9
    v_dot2_f32_bf16 v10, v63, v99, v10
    v_dot2_f32_bf16 v9, v36, v100, v9
    v_dot2_f32_bf16 v10, v64, v100, v10
    v_dot2_f32_bf16 v9, v37, v101, v9
    v_dot2_f32_bf16 v10, v65, v101, v10
    v_dot2_f32_bf16 v9, v38, v102, v9
    v_dot2_f32_bf16 v10, v66, v102, v10
    v_dot2_f32_bf16 v9, v39, v103, v9
    v_dot2_f32_bf16 v10, v67, v103, v10
    v_dot2_f32_bf16 v9, v40, v104, v9
    v_dot2_f32_bf16 v10, v68, v104, v10
    v_dot2_f32_bf16 v9, v41, v105, v9
    v_dot2_f32_bf16 v10, v69, v105, v10
    v_dot2_f32_bf16 v9, v42, v106, v9
    v_dot2_f32_bf16 v10, v70, v106, v10
    v_dot2_f32_bf16 v9, v43, v107, v9
    v_dot2_f32_bf16 v10, v71, v107, v10
    s_nop 3
    v_add_f32 v9, v9, v9 quad_perm:[1,0,3,2] row_mask:0xf bank_mask:0xf
    v_add_f32 v10, v10, v10 quad_perm:[1,0,3,2] row_mask:0xf bank_mask:0xf
    s_nop 1
    v_add_f32 v9, v9, v9 quad_perm:[2,3,0,1] row_mask:0xf bank_mask:0xf
    v_add_f32 v10, v10, v10 quad_perm:[2,3,0,1] row_mask:0xf bank_mask:0xf
    s_nop 1
    v_add_f32 v9, v9, v9 row_half_mirror row_mask:0xf bank_mask:0xf
    v_add_f32 v10, v10, v10 row_half_mirror row_mask:0xf bank_mask:0xf
    s_nop 1
    v_cndmask_b32 v9, v9, v10, s[30:31]
    v_cvt_pk_bf16_f32 v9, v9, v9
    v_and_b32 v9, 0xffff0000, v9
    v_mul_f32 v9, 0xbfb8aa3b, v9
    v_exp_f32 v9, v9
    s_nop 0
    v_add_f32 v9, 1.0, v9
    v_rcp_f32 v9, v9
    s_nop 0
    v_cvt_pk_bf16_f32 v9, v9, v9
    v_and_b32 v9, 0xffff0000, v9
    v_lshrrev_b32 v10, 3, v0
    v_lshl_add_u32 v10, v11, 3, v10
    v_lshlrev_b32 v10, 2, v10
    s_lshl_b32 s3, s3, 6
    s_add_u32 s3, s3, 8912896
    v_and_b32 v11, 7, v0
    v_cmp_gt_u32 vcc, 2, v11
    s_and_saveexec_b64 s[30:31], vcc
    buffer_store_dword v9, v10, s[12:15], s3 offen sc1
    s_mov_b64 exec, s[30:31]
    s_waitcnt vmcnt(1)
    v_lshl_or_b32 v16, v161, 16, v160
    v_lshl_or_b32 v17, v163, 16, v162
    v_lshl_or_b32 v18, v165, 16, v164
    v_lshl_or_b32 v19, v167, 16, v166
    buffer_store_dwordx4 v[16:19], v8, s[12:15], s26 offen sc1
L_26:
    v_lshl_or_b32 v20, v169, 16, v168
    v_lshl_or_b32 v21, v171, 16, v170
    v_lshl_or_b32 v22, v173, 16, v172
    v_lshl_or_b32 v23, v175, 16, v174
    buffer_store_dwordx4 v[20:23], v8, s[12:15], s27 offen sc1
L_27:
    v_lshl_or_b32 v24, v177, 16, v176
    v_lshl_or_b32 v25, v179, 16, v178
    v_lshl_or_b32 v26, v181, 16, v180
    v_lshl_or_b32 v27, v183, 16, v182
    buffer_store_dwordx4 v[24:27], v8, s[12:15], s28 offen sc1
L_28:
    s_cmp_ge_u32 s20, 2
    s_cbranch_scc1 L_29
    v_lshl_or_b32 v28, v185, 16, v184
    v_lshl_or_b32 v29, v187, 16, v186
    v_lshl_or_b32 v30, v189, 16, v188
    v_lshl_or_b32 v31, v191, 16, v190
    buffer_store_dwordx4 v[28:31], v8, s[12:15], s29 offen sc1
L_29:
    s_endpgm
.globl gm_kb_kernel
.p2align 8
.type gm_kb_kernel,@function
gm_kb_kernel:
    s_cmp_lt_u32 s2, 256
    s_cbranch_scc1 R_1001
    s_cmp_lt_u32 s2, 480
    s_cbranch_scc1 R_1002
    s_endpgm
R_1001:
    s_load_dwordx2 s[4:5], s[0:1], 104
    s_and_b32 s3, s2, 7
    s_lshl_b32 s3, s3, 1
    s_lshr_b32 s8, s2, 7
    s_add_u32 s16, s3, s8
    s_lshr_b32 s3, s2, 3
    s_and_b32 s17, s3, 15
    v_lshrrev_b32 v1, 6, v0
    v_and_b32 v0, 63, v0
    v_readfirstlane_b32 s18, v1
    v_lshlrev_b32 v1, 4, v0
    s_waitcnt lgkmcnt(0)
    s_mov_b32 s6, 0x1000000
    s_mov_b32 s7, 0x20000
    s_lshl_b32 s19, s16, 17
    s_lshl_b32 s3, s17, 13
    s_add_u32 s20, s19, s3
    s_lshl_b32 s3, s18, 15
    s_add_u32 s21, s19, s3
    s_add_u32 s22, s21, 4194304
    s_add_u32 s21, s21, 2097152
    s_add_u32 s3, s20, 0
    buffer_load_dwordx4 v[8:11], v1, s[4:7], s3 offen offset:0
    buffer_load_dwordx4 v[12:15], v1, s[4:7], s3 offen offset:1024
    s_add_u32 s3, s20, 2048
    buffer_load_dwordx4 v[16:19], v1, s[4:7], s3 offen offset:0
    buffer_load_dwordx4 v[20:23], v1, s[4:7], s3 offen offset:1024
    s_add_u32 s3, s20, 4096
    buffer_load_dwordx4 v[24:27], v1, s[4:7], s3 offen offset:0
    buffer_load_dwordx4 v[28:31], v1, s[4:7], s3 offen offset:1024
    s_add_u32 s3, s20, 6144
    buffer_load_dwordx4 v[32:35], v1, s[4:7], s3 offen offset:0
    buffer_load_dwordx4 v[36:39], v1, s[4:7], s3 offen offset:1024
    buffer_load_dwordx4 v[152:155], v1, s[4:7], s21 offen offset:0
    buffer_load_dwordx4 v[156:159], v1, s[4:7], s21 offen offset:1024
    buffer_load_dwordx4 v[184:187], v1, s[4:7], s22 offen offset:0
    buffer_load_dwordx4 v[188:191], v1, s[4:7], s22 offen offset:1024
    s_add_u32 s21, s21, 2048
    s_add_u32 s22, s22, 2048
    buffer_load_dwordx4 v[160:163], v1, s[4:7], s21 offen offset:0
    buffer_load_dwordx4 v[164:167], v1, s[4:7], s21 offen offset:1024
    buffer_load_dwordx4 v[192:195], v1, s[4:7], s22 offen offset:0
    buffer_load_dwordx4 v[196:199], v1, s[4:7], s22 offen offset:1024
    s_add_u32 s21, s21, 2048
    s_add_u32 s22, s22, 2048
    buffer_load_dwordx4 v[168:171], v1, s[4:7], s21 offen offset:0
    buffer_load_dwordx4 v[172:175], v1, s[4:7], s21 offen offset:1024
    buffer_load_dwordx4 v[200:203], v1, s[4:7], s22 offen offset:0
    buffer_load_dwordx4 v[204:207], v1, s[4:7], s22 offen offset:1024
    s_add_u32 s21, s21, 2048
    s_add_u32 s22, s22, 2048
    v_mov_b32 v40, 0
    v_mov_b32 v41, 0
    v_mov_b32 v42, 0
    v_mov_b32 v43, 0
    v_mov_b32 v44, 0
    v_mov_b32 v45, 0
    v_mov_b32 v46, 0
    v_mov_b32 v47, 0
    v_mov_b32 v48, 0
    v_mov_b32 v49, 0
    v_mov_b32 v50, 0
    v_mov_b32 v51, 0
    v_mov_b32 v52, 0
    v_mov_b32 v53, 0
    v_mov_b32 v54, 0
    v_mov_b32 v55, 0
    v_mov_b32 v56, 0
    v_mov_b32 v57, 0
    v_mov_b32 v58, 0
    v_mov_b32 v59, 0
    v_mov_b32 v60, 0
    v_mov_b32 v61, 0
    v_mov_b32 v62, 0
    v_mov_b32 v63, 0
    v_mov_b32 v64, 0
    v_mov_b32 v65, 0
    v_mov_b32 v66, 0
    v_mov_b32 v67, 0
    v_mov_b32 v68, 0
    v_mov_b32 v69, 0
    v_mov_b32 v70, 0
    v_mov_b32 v71, 0
    v_mov_b32 v72, 0
    v_mov_b32 v73, 0
    v_mov_b32 v74, 0
    v_mov_b32 v75, 0
    v_mov_b32 v76, 0
    v_mov_b32 v77, 0
    v_mov_b32 v78, 0
    v_mov_b32 v79, 0
    v_mov_b32 v80, 0
    v_mov_b32 v81, 0
    v_mov_b32 v82, 0
    v_mov_b32 v83, 0
    v_mov_b32 v84, 0
    v_mov_b32 v85, 0
    v_mov_b32 v86, 0
    v_mov_b32 v87, 0
    v_mov_b32 v88, 0
    v_mov_b32 v89, 0
    v_mov_b32 v90, 0
    v_mov_b32 v91, 0
    v_mov_b32 v92, 0
    v_mov_b32 v93, 0
    v_mov_b32 v94, 0
    v_mov_b32 v95, 0
    v_mov_b32 v96, 0
    v_mov_b32 v97, 0
    v_mov_b32 v98, 0
    v_mov_b32 v99, 0
    v_mov_b32 v100, 0
    v_mov_b32 v101, 0
    v_mov_b32 v102, 0
    v_mov_b32 v103, 0
    v_mov_b32 v144, 0
    v_mov_b32 v208, 0
    v_mov_b32 v145, 0
    v_mov_b32 v209, 0
    v_mov_b32 v146, 0
    v_mov_b32 v210, 0
    v_mov_b32 v147, 0
    v_mov_b32 v211, 0
    v_mov_b32 v148, 0
    v_mov_b32 v212, 0
    v_mov_b32 v149, 0
    v_mov_b32 v213, 0
    v_mov_b32 v150, 0
    v_mov_b32 v214, 0
    v_mov_b32 v151, 0
    v_mov_b32 v215, 0
    s_mov_b32 s23, 3
    s_mov_b32 s25, 16777216
    s_mov_b32 s27, 0x07060302
    s_waitcnt vmcnt(10)
    v_mfma_f32_32x32x16_bf16 v[104:119], v[152:155], v[8:11], 0
    v_mfma_f32_32x32x16_bf16 v[104:119], v[156:159], v[12:15], v[104:119]
    s_nop 7
    s_nop 3
ATT_1003:
    s_cmp_lt_u32 s23, 16
    s_cselect_b32 s24, s21, s25
    s_cselect_b32 s26, s22, s25
    buffer_load_dwordx4 v[176:179], v1, s[4:7], s24 offen offset:0
    buffer_load_dwordx4 v[180:183], v1, s[4:7], s24 offen offset:1024
    s_add_u32 s21, s21, 2048
    s_add_u32 s22, s22, 2048
    s_add_u32 s23, s23, 1
    v_mfma_f32_32x32x16_bf16 v[120:135], v[152:155], v[16:19], 0
    v_exp_f32 v104, v104
    v_exp_f32 v105, v105
    v_exp_f32 v106, v106
    v_exp_f32 v107, v107
    v_exp_f32 v108, v108
    v_mfma_f32_32x32x16_bf16 v[120:135], v[156:159], v[20:23], v[120:135]
    v_exp_f32 v109, v109
    v_exp_f32 v110, v110
    v_exp_f32 v111, v111
    v_exp_f32 v112, v112
    v_exp_f32 v113, v113
    v_mfma_f32_32x32x16_bf16 v[88:103], v[208:211], v[144:147], v[88:103]
    v_exp_f32 v114, v114
    v_exp_f32 v115, v115
    v_exp_f32 v116, v116
    v_exp_f32 v117, v117
    v_exp_f32 v118, v118
    v_cvt_pk_bf16_f32 v136, v104, v105
    v_cvt_pk_bf16_f32 v137, v106, v107
    v_mfma_f32_32x32x16_bf16 v[88:103], v[212:215], v[148:151], v[88:103]
    v_exp_f32 v119, v119
    v_cvt_pk_bf16_f32 v138, v108, v109
    v_cvt_pk_bf16_f32 v139, v110, v111
    v_cvt_pk_bf16_f32 v140, v112, v113
    v_cvt_pk_bf16_f32 v141, v114, v115
    v_cvt_pk_bf16_f32 v142, v116, v117
    v_cvt_pk_bf16_f32 v143, v118, v119
    s_waitcnt vmcnt(10)
    buffer_load_dwordx4 v[208:211], v1, s[4:7], s26 offen offset:0
    buffer_load_dwordx4 v[212:215], v1, s[4:7], s26 offen offset:1024
    v_mfma_f32_32x32x16_bf16 v[104:119], v[152:155], v[24:27], 0
    v_exp_f32 v120, v120
    v_exp_f32 v121, v121
    v_exp_f32 v122, v122
    v_exp_f32 v123, v123
    v_exp_f32 v124, v124
    v_mfma_f32_32x32x16_bf16 v[104:119], v[156:159], v[28:31], v[104:119]
    v_exp_f32 v125, v125
    v_exp_f32 v126, v126
    v_exp_f32 v127, v127
    v_exp_f32 v128, v128
    v_exp_f32 v129, v129
    v_mfma_f32_32x32x16_bf16 v[40:55], v[184:187], v[136:139], v[40:55]
    v_exp_f32 v130, v130
    v_exp_f32 v131, v131
    v_exp_f32 v132, v132
    v_exp_f32 v133, v133
    v_exp_f32 v134, v134
    v_cvt_pk_bf16_f32 v144, v120, v121
    v_cvt_pk_bf16_f32 v145, v122, v123
    v_mfma_f32_32x32x16_bf16 v[40:55], v[188:191], v[140:143], v[40:55]
    v_exp_f32 v135, v135
    v_cvt_pk_bf16_f32 v146, v124, v125
    v_cvt_pk_bf16_f32 v147, v126, v127
    v_cvt_pk_bf16_f32 v148, v128, v129
    v_cvt_pk_bf16_f32 v149, v130, v131
    v_cvt_pk_bf16_f32 v150, v132, v133
    v_cvt_pk_bf16_f32 v151, v134, v135
    v_mfma_f32_32x32x16_bf16 v[120:135], v[152:155], v[32:35], 0
    v_exp_f32 v104, v104
    v_exp_f32 v105, v105
    v_exp_f32 v106, v106
    v_exp_f32 v107, v107
    v_exp_f32 v108, v108
    v_mfma_f32_32x32x16_bf16 v[120:135], v[156:159], v[36:39], v[120:135]
    v_exp_f32 v109, v109
    v_exp_f32 v110, v110
    v_exp_f32 v111, v111
    v_exp_f32 v112, v112
    v_exp_f32 v113, v113
    v_mfma_f32_32x32x16_bf16 v[56:71], v[184:187], v[144:147], v[56:71]
    v_exp_f32 v114, v114
    v_exp_f32 v115, v115
    v_exp_f32 v116, v116
    v_exp_f32 v117, v117
    v_exp_f32 v118, v118
    v_cvt_pk_bf16_f32 v136, v104, v105
    v_cvt_pk_bf16_f32 v137, v106, v107
    v_mfma_f32_32x32x16_bf16 v[56:71], v[188:191], v[148:151], v[56:71]
    v_exp_f32 v119, v119
    v_cvt_pk_bf16_f32 v138, v108, v109
    v_cvt_pk_bf16_f32 v139, v110, v111
    v_cvt_pk_bf16_f32 v140, v112, v113
    v_cvt_pk_bf16_f32 v141, v114, v115
    v_cvt_pk_bf16_f32 v142, v116, v117
    v_cvt_pk_bf16_f32 v143, v118, v119
    s_waitcnt vmcnt(10)
    v_mfma_f32_32x32x16_bf16 v[104:119], v[160:163], v[8:11], 0
    v_exp_f32 v120, v120
    v_exp_f32 v121, v121
    v_exp_f32 v122, v122
    v_exp_f32 v123, v123
    v_exp_f32 v124, v124
    v_mfma_f32_32x32x16_bf16 v[104:119], v[164:167], v[12:15], v[104:119]
    v_exp_f32 v125, v125
    v_exp_f32 v126, v126
    v_exp_f32 v127, v127
    v_exp_f32 v128, v128
    v_exp_f32 v129, v129
    v_mfma_f32_32x32x16_bf16 v[72:87], v[184:187], v[136:139], v[72:87]
    v_exp_f32 v130, v130
    v_exp_f32 v131, v131
    v_exp_f32 v132, v132
    v_exp_f32 v133, v133
    v_exp_f32 v134, v134
    v_cvt_pk_bf16_f32 v144, v120, v121
    v_cvt_pk_bf16_f32 v145, v122, v123
    v_mfma_f32_32x32x16_bf16 v[72:87], v[188:191], v[140:143], v[72:87]
    v_exp_f32 v135, v135
    v_cvt_pk_bf16_f32 v146, v124, v125
    v_cvt_pk_bf16_f32 v147, v126, v127
    v_cvt_pk_bf16_f32 v148, v128, v129
    v_cvt_pk_bf16_f32 v149, v130, v131
    v_cvt_pk_bf16_f32 v150, v132, v133
    v_cvt_pk_bf16_f32 v151, v134, v135
    s_cmp_lt_u32 s23, 16
    s_cselect_b32 s24, s21, s25
    s_cselect_b32 s26, s22, s25
    buffer_load_dwordx4 v[152:155], v1, s[4:7], s24 offen offset:0
    buffer_load_dwordx4 v[156:159], v1, s[4:7], s24 offen offset:1024
    s_add_u32 s21, s21, 2048
    s_add_u32 s22, s22, 2048
    s_add_u32 s23, s23, 1
    v_mfma_f32_32x32x16_bf16 v[120:135], v[160:163], v[16:19], 0
    v_exp_f32 v104, v104
    v_exp_f32 v105, v105
    v_exp_f32 v106, v106
    v_exp_f32 v107, v107
    v_exp_f32 v108, v108
    v_mfma_f32_32x32x16_bf16 v[120:135], v[164:167], v[20:23], v[120:135]
    v_exp_f32 v109, v109
    v_exp_f32 v110, v110
    v_exp_f32 v111, v111
    v_exp_f32 v112, v112
    v_exp_f32 v113, v113
    v_mfma_f32_32x32x16_bf16 v[88:103], v[184:187], v[144:147], v[88:103]
    v_exp_f32 v114, v114
    v_exp_f32 v115, v115
    v_exp_f32 v116, v116
    v_exp_f32 v117, v117
    v_exp_f32 v118, v118
    v_cvt_pk_bf16_f32 v136, v104, v105
    v_cvt_pk_bf16_f32 v137, v106, v107
    v_mfma_f32_32x32x16_bf16 v[88:103], v[188:191], v[148:151], v[88:103]
    v_exp_f32 v119, v119
    v_cvt_pk_bf16_f32 v138, v108, v109
    v_cvt_pk_bf16_f32 v139, v110, v111
    v_cvt_pk_bf16_f32 v140, v112, v113
    v_cvt_pk_bf16_f32 v141, v114, v115
    v_cvt_pk_bf16_f32 v142, v116, v117
    v_cvt_pk_bf16_f32 v143, v118, v119
    s_waitcnt vmcnt(10)
    buffer_load_dwordx4 v[184:187], v1, s[4:7], s26 offen offset:0
    buffer_load_dwordx4 v[188:191], v1, s[4:7], s26 offen offset:1024
    v_mfma_f32_32x32x16_bf16 v[104:119], v[160:163], v[24:27], 0
    v_exp_f32 v120, v120
    v_exp_f32 v121, v121
    v_exp_f32 v122, v122
    v_exp_f32 v123, v123
    v_exp_f32 v124, v124
    v_mfma_f32_32x32x16_bf16 v[104:119], v[164:167], v[28:31], v[104:119]
    v_exp_f32 v125, v125
    v_exp_f32 v126, v126
    v_exp_f32 v127, v127
    v_exp_f32 v128, v128
    v_exp_f32 v129, v129
    v_mfma_f32_32x32x16_bf16 v[40:55], v[192:195], v[136:139], v[40:55]
    v_exp_f32 v130, v130
    v_exp_f32 v131, v131
    v_exp_f32 v132, v132
    v_exp_f32 v133, v133
    v_exp_f32 v134, v134
    v_cvt_pk_bf16_f32 v144, v120, v121
    v_cvt_pk_bf16_f32 v145, v122, v123
    v_mfma_f32_32x32x16_bf16 v[40:55], v[196:199], v[140:143], v[40:55]
    v_exp_f32 v135, v135
    v_cvt_pk_bf16_f32 v146, v124, v125
    v_cvt_pk_bf16_f32 v147, v126, v127
    v_cvt_pk_bf16_f32 v148, v128, v129
    v_cvt_pk_bf16_f32 v149, v130, v131
    v_cvt_pk_bf16_f32 v150, v132, v133
    v_cvt_pk_bf16_f32 v151, v134, v135
    v_mfma_f32_32x32x16_bf16 v[120:135], v[160:163], v[32:35], 0
    v_exp_f32 v104, v104
    v_exp_f32 v105, v105
    v_exp_f32 v106, v106
    v_exp_f32 v107, v107
    v_exp_f32 v108, v108
    v_mfma_f32_32x32x16_bf16 v[120:135], v[164:167], v[36:39], v[120:135]
    v_exp_f32 v109, v109
    v_exp_f32 v110, v110
    v_exp_f32 v111, v111
    v_exp_f32 v112, v112
    v_exp_f32 v113, v113
    v_mfma_f32_32x32x16_bf16 v[56:71], v[192:195], v[144:147], v[56:71]
    v_exp_f32 v114, v114
    v_exp_f32 v115, v115
    v_exp_f32 v116, v116
    v_exp_f32 v117, v117
    v_exp_f32 v118, v118
    v_cvt_pk_bf16_f32 v136, v104, v105
    v_cvt_pk_bf16_f32 v137, v106, v107
    v_mfma_f32_32x32x16_bf16 v[56:71], v[196:199], v[148:151], v[56:71]
    v_exp_f32 v119, v119
    v_cvt_pk_bf16_f32 v138, v108, v109
    v_cvt_pk_bf16_f32 v139, v110, v111
    v_cvt_pk_bf16_f32 v140, v112, v113
    v_cvt_pk_bf16_f32 v141, v114, v115
    v_cvt_pk_bf16_f32 v142, v116, v117
    v_cvt_pk_bf16_f32 v143, v118, v119
    s_waitcnt vmcnt(10)
    v_mfma_f32_32x32x16_bf16 v[104:119], v[168:171], v[8:11], 0
    v_exp_f32 v120, v120
    v_exp_f32 v121, v121
    v_exp_f32 v122, v122
    v_exp_f32 v123, v123
    v_exp_f32 v124, v124
    v_mfma_f32_32x32x16_bf16 v[104:119], v[172:175], v[12:15], v[104:119]
    v_exp_f32 v125, v125
    v_exp_f32 v126, v126
    v_exp_f32 v127, v127
    v_exp_f32 v128, v128
    v_exp_f32 v129, v129
    v_mfma_f32_32x32x16_bf16 v[72:87], v[192:195], v[136:139], v[72:87]
    v_exp_f32 v130, v130
    v_exp_f32 v131, v131
    v_exp_f32 v132, v132
    v_exp_f32 v133, v133
    v_exp_f32 v134, v134
    v_cvt_pk_bf16_f32 v144, v120, v121
    v_cvt_pk_bf16_f32 v145, v122, v123
    v_mfma_f32_32x32x16_bf16 v[72:87], v[196:199], v[140:143], v[72:87]
    v_exp_f32 v135, v135
    v_cvt_pk_bf16_f32 v146, v124, v125
    v_cvt_pk_bf16_f32 v147, v126, v127
    v_cvt_pk_bf16_f32 v148, v128, v129
    v_cvt_pk_bf16_f32 v149, v130, v131
    v_cvt_pk_bf16_f32 v150, v132, v133
    v_cvt_pk_bf16_f32 v151, v134, v135
    s_cmp_lt_u32 s23, 16
    s_cselect_b32 s24, s21, s25
    s_cselect_b32 s26, s22, s25
    buffer_load_dwordx4 v[160:163], v1, s[4:7], s24 offen offset:0
    buffer_load_dwordx4 v[164:167], v1, s[4:7], s24 offen offset:1024
    s_add_u32 s21, s21, 2048
    s_add_u32 s22, s22, 2048
    s_add_u32 s23, s23, 1
    v_mfma_f32_32x32x16_bf16 v[120:135], v[168:171], v[16:19], 0
    v_exp_f32 v104, v104
    v_exp_f32 v105, v105
    v_exp_f32 v106, v106
    v_exp_f32 v107, v107
    v_exp_f32 v108, v108
    v_mfma_f32_32x32x16_bf16 v[120:135], v[172:175], v[20:23], v[120:135]
    v_exp_f32 v109, v109
    v_exp_f32 v110, v110
    v_exp_f32 v111, v111
    v_exp_f32 v112, v112
    v_exp_f32 v113, v113
    v_mfma_f32_32x32x16_bf16 v[88:103], v[192:195], v[144:147], v[88:103]
    v_exp_f32 v114, v114
    v_exp_f32 v115, v115
    v_exp_f32 v116, v116
    v_exp_f32 v117, v117
    v_exp_f32 v118, v118
    v_cvt_pk_bf16_f32 v136, v104, v105
    v_cvt_pk_bf16_f32 v137, v106, v107
    v_mfma_f32_32x32x16_bf16 v[88:103], v[196:199], v[148:151], v[88:103]
    v_exp_f32 v119, v119
    v_cvt_pk_bf16_f32 v138, v108, v109
    v_cvt_pk_bf16_f32 v139, v110, v111
    v_cvt_pk_bf16_f32 v140, v112, v113
    v_cvt_pk_bf16_f32 v141, v114, v115
    v_cvt_pk_bf16_f32 v142, v116, v117
    v_cvt_pk_bf16_f32 v143, v118, v119
    s_waitcnt vmcnt(10)
    buffer_load_dwordx4 v[192:195], v1, s[4:7], s26 offen offset:0
    buffer_load_dwordx4 v[196:199], v1, s[4:7], s26 offen offset:1024
    v_mfma_f32_32x32x16_bf16 v[104:119], v[168:171], v[24:27], 0
    v_exp_f32 v120, v120
    v_exp_f32 v121, v121
    v_exp_f32 v122, v122
    v_exp_f32 v123, v123
    v_exp_f32 v124, v124
    v_mfma_f32_32x32x16_bf16 v[104:119], v[172:175], v[28:31], v[104:119]
    v_exp_f32 v125, v125
    v_exp_f32 v126, v126
    v_exp_f32 v127, v127
    v_exp_f32 v128, v128
    v_exp_f32 v129, v129
    v_mfma_f32_32x32x16_bf16 v[40:55], v[200:203], v[136:139], v[40:55]
    v_exp_f32 v130, v130
    v_exp_f32 v131, v131
    v_exp_f32 v132, v132
    v_exp_f32 v133, v133
    v_exp_f32 v134, v134
    v_cvt_pk_bf16_f32 v144, v120, v121
    v_cvt_pk_bf16_f32 v145, v122, v123
    v_mfma_f32_32x32x16_bf16 v[40:55], v[204:207], v[140:143], v[40:55]
    v_exp_f32 v135, v135
    v_cvt_pk_bf16_f32 v146, v124, v125
    v_cvt_pk_bf16_f32 v147, v126, v127
    v_cvt_pk_bf16_f32 v148, v128, v129
    v_cvt_pk_bf16_f32 v149, v130, v131
    v_cvt_pk_bf16_f32 v150, v132, v133
    v_cvt_pk_bf16_f32 v151, v134, v135
    v_mfma_f32_32x32x16_bf16 v[120:135], v[168:171], v[32:35], 0
    v_exp_f32 v104, v104
    v_exp_f32 v105, v105
    v_exp_f32 v106, v106
    v_exp_f32 v107, v107
    v_exp_f32 v108, v108
    v_mfma_f32_32x32x16_bf16 v[120:135], v[172:175], v[36:39], v[120:135]
    v_exp_f32 v109, v109
    v_exp_f32 v110, v110
    v_exp_f32 v111, v111
    v_exp_f32 v112, v112
    v_exp_f32 v113, v113
    v_mfma_f32_32x32x16_bf16 v[56:71], v[200:203], v[144:147], v[56:71]
    v_exp_f32 v114, v114
    v_exp_f32 v115, v115
    v_exp_f32 v116, v116
    v_exp_f32 v117, v117
    v_exp_f32 v118, v118
    v_cvt_pk_bf16_f32 v136, v104, v105
    v_cvt_pk_bf16_f32 v137, v106, v107
    v_mfma_f32_32x32x16_bf16 v[56:71], v[204:207], v[148:151], v[56:71]
    v_exp_f32 v119, v119
    v_cvt_pk_bf16_f32 v138, v108, v109
    v_cvt_pk_bf16_f32 v139, v110, v111
    v_cvt_pk_bf16_f32 v140, v112, v113
    v_cvt_pk_bf16_f32 v141, v114, v115
    v_cvt_pk_bf16_f32 v142, v116, v117
    v_cvt_pk_bf16_f32 v143, v118, v119
    s_waitcnt vmcnt(10)
    v_mfma_f32_32x32x16_bf16 v[104:119], v[176:179], v[8:11], 0
    v_exp_f32 v120, v120
    v_exp_f32 v121, v121
    v_exp_f32 v122, v122
    v_exp_f32 v123, v123
    v_exp_f32 v124, v124
    v_mfma_f32_32x32x16_bf16 v[104:119], v[180:183], v[12:15], v[104:119]
    v_exp_f32 v125, v125
    v_exp_f32 v126, v126
    v_exp_f32 v127, v127
    v_exp_f32 v128, v128
    v_exp_f32 v129, v129
    v_mfma_f32_32x32x16_bf16 v[72:87], v[200:203], v[136:139], v[72:87]
    v_exp_f32 v130, v130
    v_exp_f32 v131, v131
    v_exp_f32 v132, v132
    v_exp_f32 v133, v133
    v_exp_f32 v134, v134
    v_cvt_pk_bf16_f32 v144, v120, v121
    v_cvt_pk_bf16_f32 v145, v122, v123
    v_mfma_f32_32x32x16_bf16 v[72:87], v[204:207], v[140:143], v[72:87]
    v_exp_f32 v135, v135
    v_cvt_pk_bf16_f32 v146, v124, v125
    v_cvt_pk_bf16_f32 v147, v126, v127
    v_cvt_pk_bf16_f32 v148, v128, v129
    v_cvt_pk_bf16_f32 v149, v130, v131
    v_cvt_pk_bf16_f32 v150, v132, v133
    v_cvt_pk_bf16_f32 v151, v134, v135
    s_cmp_lt_u32 s23, 16
    s_cselect_b32 s24, s21, s25
    s_cselect_b32 s26, s22, s25
    buffer_load_dwordx4 v[168:171], v1, s[4:7], s24 offen offset:0
    buffer_load_dwordx4 v[172:175], v1, s[4:7], s24 offen offset:1024
    s_add_u32 s21, s21, 2048
    s_add_u32 s22, s22, 2048
    s_add_u32 s23, s23, 1
    v_mfma_f32_32x32x16_bf16 v[120:135], v[176:179], v[16:19], 0
    v_exp_f32 v104, v104
    v_exp_f32 v105, v105
    v_exp_f32 v106, v106
    v_exp_f32 v107, v107
    v_exp_f32 v108, v108
    v_mfma_f32_32x32x16_bf16 v[120:135], v[180:183], v[20:23], v[120:135]
    v_exp_f32 v109, v109
    v_exp_f32 v110, v110
    v_exp_f32 v111, v111
    v_exp_f32 v112, v112
    v_exp_f32 v113, v113
    v_mfma_f32_32x32x16_bf16 v[88:103], v[200:203], v[144:147], v[88:103]
    v_exp_f32 v114, v114
    v_exp_f32 v115, v115
    v_exp_f32 v116, v116
    v_exp_f32 v117, v117
    v_exp_f32 v118, v118
    v_cvt_pk_bf16_f32 v136, v104, v105
    v_cvt_pk_bf16_f32 v137, v106, v107
    v_mfma_f32_32x32x16_bf16 v[88:103], v[204:207], v[148:151], v[88:103]
    v_exp_f32 v119, v119
    v_cvt_pk_bf16_f32 v138, v108, v109
    v_cvt_pk_bf16_f32 v139, v110, v111
    v_cvt_pk_bf16_f32 v140, v112, v113
    v_cvt_pk_bf16_f32 v141, v114, v115
    v_cvt_pk_bf16_f32 v142, v116, v117
    v_cvt_pk_bf16_f32 v143, v118, v119
    s_waitcnt vmcnt(10)
    buffer_load_dwordx4 v[200:203], v1, s[4:7], s26 offen offset:0
    buffer_load_dwordx4 v[204:207], v1, s[4:7], s26 offen offset:1024
    v_mfma_f32_32x32x16_bf16 v[104:119], v[176:179], v[24:27], 0
    v_exp_f32 v120, v120
    v_exp_f32 v121, v121
    v_exp_f32 v122, v122
    v_exp_f32 v123, v123
    v_exp_f32 v124, v124
    v_mfma_f32_32x32x16_bf16 v[104:119], v[180:183], v[28:31], v[104:119]
    v_exp_f32 v125, v125
    v_exp_f32 v126, v126
    v_exp_f32 v127, v127
    v_exp_f32 v128, v128
    v_exp_f32 v129, v129
    v_mfma_f32_32x32x16_bf16 v[40:55], v[208:211], v[136:139], v[40:55]
    v_exp_f32 v130, v130
    v_exp_f32 v131, v131
    v_exp_f32 v132, v132
    v_exp_f32 v133, v133
    v_exp_f32 v134, v134
    v_cvt_pk_bf16_f32 v144, v120, v121
    v_cvt_pk_bf16_f32 v145, v122, v123
    v_mfma_f32_32x32x16_bf16 v[40:55], v[212:215], v[140:143], v[40:55]
    v_exp_f32 v135, v135
    v_cvt_pk_bf16_f32 v146, v124, v125
    v_cvt_pk_bf16_f32 v147, v126, v127
    v_cvt_pk_bf16_f32 v148, v128, v129
    v_cvt_pk_bf16_f32 v149, v130, v131
    v_cvt_pk_bf16_f32 v150, v132, v133
    v_cvt_pk_bf16_f32 v151, v134, v135
    v_mfma_f32_32x32x16_bf16 v[120:135], v[176:179], v[32:35], 0
    v_exp_f32 v104, v104
    v_exp_f32 v105, v105
    v_exp_f32 v106, v106
    v_exp_f32 v107, v107
    v_exp_f32 v108, v108
    v_mfma_f32_32x32x16_bf16 v[120:135], v[180:183], v[36:39], v[120:135]
    v_exp_f32 v109, v109
    v_exp_f32 v110, v110
    v_exp_f32 v111, v111
    v_exp_f32 v112, v112
    v_exp_f32 v113, v113
    v_mfma_f32_32x32x16_bf16 v[56:71], v[208:211], v[144:147], v[56:71]
    v_exp_f32 v114, v114
    v_exp_f32 v115, v115
    v_exp_f32 v116, v116
    v_exp_f32 v117, v117
    v_exp_f32 v118, v118
    v_cvt_pk_bf16_f32 v136, v104, v105
    v_cvt_pk_bf16_f32 v137, v106, v107
    v_mfma_f32_32x32x16_bf16 v[56:71], v[212:215], v[148:151], v[56:71]
    v_exp_f32 v119, v119
    v_cvt_pk_bf16_f32 v138, v108, v109
    v_cvt_pk_bf16_f32 v139, v110, v111
    v_cvt_pk_bf16_f32 v140, v112, v113
    v_cvt_pk_bf16_f32 v141, v114, v115
    v_cvt_pk_bf16_f32 v142, v116, v117
    v_cvt_pk_bf16_f32 v143, v118, v119
    s_waitcnt vmcnt(10)
    v_mfma_f32_32x32x16_bf16 v[104:119], v[152:155], v[8:11], 0
    v_exp_f32 v120, v120
    v_exp_f32 v121, v121
    v_exp_f32 v122, v122
    v_exp_f32 v123, v123
    v_exp_f32 v124, v124
    v_mfma_f32_32x32x16_bf16 v[104:119], v[156:159], v[12:15], v[104:119]
    v_exp_f32 v125, v125
    v_exp_f32 v126, v126
    v_exp_f32 v127, v127
    v_exp_f32 v128, v128
    v_exp_f32 v129, v129
    v_mfma_f32_32x32x16_bf16 v[72:87], v[208:211], v[136:139], v[72:87]
    v_exp_f32 v130, v130
    v_exp_f32 v131, v131
    v_exp_f32 v132, v132
    v_exp_f32 v133, v133
    v_exp_f32 v134, v134
    v_cvt_pk_bf16_f32 v144, v120, v121
    v_cvt_pk_bf16_f32 v145, v122, v123
    v_mfma_f32_32x32x16_bf16 v[72:87], v[212:215], v[140:143], v[72:87]
    v_exp_f32 v135, v135
    v_cvt_pk_bf16_f32 v146, v124, v125
    v_cvt_pk_bf16_f32 v147, v126, v127
    v_cvt_pk_bf16_f32 v148, v128, v129
    v_cvt_pk_bf16_f32 v149, v130, v131
    v_cvt_pk_bf16_f32 v150, v132, v133
    v_cvt_pk_bf16_f32 v151, v134, v135
    s_cmp_lt_u32 s23, 19
    s_cbranch_scc1 ATT_1003
    s_nop 1
    v_mfma_f32_32x32x16_bf16 v[88:103], v[208:211], v[144:147], v[88:103]
    v_mfma_f32_32x32x16_bf16 v[88:103], v[212:215], v[148:151], v[88:103]
    s_nop 7
    s_nop 7
    s_lshl_b32 s3, s18, 12
    v_add_u32 v2, s3, v1
    s_lshl_b32 s3, s18, 14
    v_add_u32 v3, s3, v1
    s_cmp_eq_u32 s18, 0
    s_cbranch_scc1 L_1004
    ds_write_b128 v2, v[40:43] offset:0
    ds_write_b128 v2, v[44:47] offset:1024
    ds_write_b128 v2, v[48:51] offset:2048
    ds_write_b128 v2, v[52:55] offset:3072
    s_branch L_1005
L_1004:
    v_mov_b32 v104, v40
    v_mov_b32 v105, v41
    v_mov_b32 v106, v42
    v_mov_b32 v107, v43
    v_mov_b32 v108, v44
    v_mov_b32 v109, v45
    v_mov_b32 v110, v46
    v_mov_b32 v111, v47
    v_mov_b32 v112, v48
    v_mov_b32 v113, v49
    v_mov_b32 v114, v50
    v_mov_b32 v115, v51
    v_mov_b32 v116, v52
    v_mov_b32 v117, v53
    v_mov_b32 v118, v54
    v_mov_b32 v119, v55
L_1005:
    s_cmp_eq_u32 s18, 1
    s_cbranch_scc1 L_1006
    ds_write_b128 v2, v[56:59] offset:16384
    ds_write_b128 v2, v[60:63] offset:17408
    ds_write_b128 v2, v[64:67] offset:18432
    ds_write_b128 v2, v[68:71] offset:19456
    s_branch L_1007
L_1006:
    v_mov_b32 v104, v56
    v_mov_b32 v105, v57
    v_mov_b32 v106, v58
    v_mov_b32 v107, v59
    v_mov_b32 v108, v60
    v_mov_b32 v109, v61
    v_mov_b32 v110, v62
    v_mov_b32 v111, v63
    v_mov_b32 v112, v64
    v_mov_b32 v113, v65
    v_mov_b32 v114, v66
    v_mov_b32 v115, v67
    v_mov_b32 v116, v68
    v_mov_b32 v117, v69
    v_mov_b32 v118, v70
    v_mov_b32 v119, v71
L_1007:
    s_cmp_eq_u32 s18, 2
    s_cbranch_scc1 L_1008
    ds_write_b128 v2, v[72:75] offset:32768
    ds_write_b128 v2, v[76:79] offset:33792
    ds_write_b128 v2, v[80:83] offset:34816
    ds_write_b128 v2, v[84:87] offset:35840
    s_branch L_1009
L_1008:
    v_mov_b32 v104, v72
    v_mov_b32 v105, v73
    v_mov_b32 v106, v74
    v_mov_b32 v107, v75
    v_mov_b32 v108, v76
    v_mov_b32 v109, v77
    v_mov_b32 v110, v78
    v_mov_b32 v111, v79
    v_mov_b32 v112, v80
    v_mov_b32 v113, v81
    v_mov_b32 v114, v82
    v_mov_b32 v115, v83
    v_mov_b32 v116, v84
    v_mov_b32 v117, v85
    v_mov_b32 v118, v86
    v_mov_b32 v119, v87
L_1009:
    s_cmp_eq_u32 s18, 3
    s_cbranch_scc1 L_1010
    ds_write_b128 v2, v[88:91] offset:49152
    ds_write_b128 v2, v[92:95] offset:50176
    ds_write_b128 v2, v[96:99] offset:51200
    ds_write_b128 v2, v[100:103] offset:52224
    s_branch L_1011
L_1010:
    v_mov_b32 v104, v88
    v_mov_b32 v105, v89
    v_mov_b32 v106, v90
    v_mov_b32 v107, v91
    v_mov_b32 v108, v92
    v_mov_b32 v109, v93
    v_mov_b32 v110, v94
    v_mov_b32 v111, v95
    v_mov_b32 v112, v96
    v_mov_b32 v113, v97
    v_mov_b32 v114, v98
    v_mov_b32 v115, v99
    v_mov_b32 v116, v100
    v_mov_b32 v117, v101
    v_mov_b32 v118, v102
    v_mov_b32 v119, v103
L_1011:
    s_waitcnt lgkmcnt(0)
    s_barrier
    s_add_u32 s3, s18, 1
    s_and_b32 s3, s3, 3
    s_lshl_b32 s3, s3, 12
    v_add_u32 v4, s3, v3
    ds_read_b128 v[40:43], v4 offset:0
    ds_read_b128 v[44:47], v4 offset:1024
    ds_read_b128 v[48:51], v4 offset:2048
    ds_read_b128 v[52:55], v4 offset:3072
    s_add_u32 s3, s18, 2
    s_and_b32 s3, s3, 3
    s_lshl_b32 s3, s3, 12
    v_add_u32 v5, s3, v3
    ds_read_b128 v[56:59], v5 offset:0
    ds_read_b128 v[60:63], v5 offset:1024
    ds_read_b128 v[64:67], v5 offset:2048
    ds_read_b128 v[68:71], v5 offset:3072
    s_add_u32 s3, s18, 3
    s_and_b32 s3, s3, 3
    s_lshl_b32 s3, s3, 12
    v_add_u32 v6, s3, v3
    ds_read_b128 v[72:75], v6 offset:0
    ds_read_b128 v[76:79], v6 offset:1024
    ds_read_b128 v[80:83], v6 offset:2048
    ds_read_b128 v[84:87], v6 offset:3072
    s_waitcnt lgkmcnt(8)
    v_add_f32 v104, v104, v40
    v_add_f32 v105, v105, v41
    v_add_f32 v106, v106, v42
    v_add_f32 v107, v107, v43
    v_add_f32 v108, v108, v44
    v_add_f32 v109, v109, v45
    v_add_f32 v110, v110, v46
    v_add_f32 v111, v111, v47
    v_add_f32 v112, v112, v48
    v_add_f32 v113, v113, v49
    v_add_f32 v114, v114, v50
    v_add_f32 v115, v115, v51
    v_add_f32 v116, v116, v52
    v_add_f32 v117, v117, v53
    v_add_f32 v118, v118, v54
    v_add_f32 v119, v119, v55
    s_waitcnt lgkmcnt(4)
    v_add_f32 v104, v104, v56
    v_add_f32 v105, v105, v57
    v_add_f32 v106, v106, v58
    v_add_f32 v107, v107, v59
    v_add_f32 v108, v108, v60
    v_add_f32 v109, v109, v61
    v_add_f32 v110, v110, v62
    v_add_f32 v111, v111, v63
    v_add_f32 v112, v112, v64
    v_add_f32 v113, v113, v65
    v_add_f32 v114, v114, v66
    v_add_f32 v115, v115, v67
    v_add_f32 v116, v116, v68
    v_add_f32 v117, v117, v69
    v_add_f32 v118, v118, v70
    v_add_f32 v119, v119, v71
    s_waitcnt lgkmcnt(0)
    v_add_f32 v104, v104, v72
    v_add_f32 v105, v105, v73
    v_add_f32 v106, v106, v74
    v_add_f32 v107, v107, v75
    v_add_f32 v108, v108, v76
    v_add_f32 v109, v109, v77
    v_add_f32 v110, v110, v78
    v_add_f32 v111, v111, v79
    v_add_f32 v112, v112, v80
    v_add_f32 v113, v113, v81
    v_add_f32 v114, v114, v82
    v_add_f32 v115, v115, v83
    v_add_f32 v116, v116, v84
    v_add_f32 v117, v117, v85
    v_add_f32 v118, v118, v86
    v_add_f32 v119, v119, v87
    v_mov_b32 v8, v116
    v_mov_b32 v9, v116
    s_nop 1
    v_permlane32_swap_b32 v8, v9
    v_max3_f32 v10, |v104|, |v105|, |v106|
    v_max3_f32 v10, |v107|, |v108|, v10
    v_max3_f32 v10, |v109|, |v110|, v10
    v_max3_f32 v10, |v111|, |v112|, v10
    v_max3_f32 v10, |v113|, |v114|, v10
    v_max3_f32 v10, |v115|, |v116|, v10
    v_max3_f32 v10, |v117|, |v118|, v10
    v_max_f32 v10, |v119|, v10
    s_mov_b32 s8, 0x2b800000
    s_mov_b32 s9, 0x53800000
    s_mov_b32 s10, 0x7e800000
    v_cmp_le_f32 s[12:13], s8, v9
    v_cmp_ge_f32 s[14:15], s9, v9
    v_cmp_ge_f32 vcc, s10, v10
    s_and_b64 s[12:13], s[12:13], s[14:15]
    s_and_b64 vcc, vcc, s[12:13]
    s_cmp_eq_u64 vcc, -1
    s_cbranch_scc0 FB_1013
FIN_1012:
    v_rcp_f32 v9, v9
    s_nop 0
    v_mul_f32 v104, v104, v9
    v_mul_f32 v105, v105, v9
    v_mul_f32 v106, v106, v9
    v_mul_f32 v107, v107, v9
    v_mul_f32 v108, v108, v9
    v_mul_f32 v109, v109, v9
    v_mul_f32 v110, v110, v9
    v_mul_f32 v111, v111, v9
    v_mul_f32 v112, v112, v9
    v_mul_f32 v113, v113, v9
    v_mul_f32 v114, v114, v9
    v_mul_f32 v115, v115, v9
    v_mul_f32 v116, v116, v9
    v_mul_f32 v117, v117, v9
    v_mul_f32 v118, v118, v9
    v_mul_f32 v119, v119, v9
    v_cvt_pk_bf16_f32 v136, v104, v105
    v_cvt_pk_bf16_f32 v137, v106, v107
    v_cvt_pk_bf16_f32 v138, v108, v109
    v_cvt_pk_bf16_f32 v139, v110, v111
    v_cvt_pk_bf16_f32 v140, v112, v113
    v_cvt_pk_bf16_f32 v141, v114, v115
    v_cvt_pk_bf16_f32 v142, v116, v117
    v_cvt_pk_bf16_f32 v143, v118, v119
    s_lshl_b32 s3, s17, 2
    s_add_u32 s3, s3, s18
    s_lshl_b32 s3, s3, 4
    s_add_u32 s3, s3, s16
    s_lshl_b32 s3, s3, 11
    s_add_u32 s3, s3, 6291456
    buffer_store_dwordx4 v[136:139], v1, s[4:7], s3 offen sc1
    buffer_store_dwordx4 v[140:143], v1, s[4:7], s3 offen offset:1024 sc1
    s_endpgm
FB_1013:
    s_lshl_b32 s3, s18, 11
    s_add_u32 s3, s3, s20
    buffer_load_dwordx4 v[8:11], v1, s[4:7], s3 offen
    buffer_load_dwordx4 v[12:15], v1, s[4:7], s3 offen offset:1024
    s_add_u32 s21, s19, 2097152
    s_mov_b32 s23, 0
    v_mov_b32 v2, 0xff800000
L_1014:
    buffer_load_dwordx4 v[152:155], v1, s[4:7], s21 offen offset:0
    buffer_load_dwordx4 v[156:159], v1, s[4:7], s21 offen offset:1024
    s_waitcnt vmcnt(0)
    v_mfma_f32_32x32x16_bf16 v[40:55], v[152:155], v[8:11], 0
    v_mfma_f32_32x32x16_bf16 v[40:55], v[156:159], v[12:15], v[40:55]
    s_nop 7
    s_nop 7
    v_max3_f32 v2, v40, v41, v2
    v_max3_f32 v2, v42, v43, v2
    v_max3_f32 v2, v44, v45, v2
    v_max3_f32 v2, v46, v47, v2
    v_max3_f32 v2, v48, v49, v2
    v_max3_f32 v2, v50, v51, v2
    v_max3_f32 v2, v52, v53, v2
    v_max3_f32 v2, v54, v55, v2
    s_add_u32 s21, s21, 2048
    s_add_u32 s23, s23, 1
    s_cmp_lt_u32 s23, 64
    s_cbranch_scc1 L_1014
    v_mov_b32 v3, v2
    s_nop 1
    v_permlane32_swap_b32 v2, v3
    s_nop 1
    v_max_f32 v2, v2, v3
    v_cvt_pk_bf16_f32 v3, v2, v2
    v_lshlrev_b32 v3, 16, v3
    v_sub_f32 v2, v2, v3
    v_cvt_pk_bf16_f32 v4, v2, v2
    v_lshlrev_b32 v4, 16, v4
    v_sub_f32 v2, v2, v4
    v_cvt_pk_bf16_f32 v3, -v3, -v4
    v_cvt_pk_bf16_f32 v4, -v2, 0
    v_cmp_lt_u32 vcc, 31, v0
    s_nop 1
    v_cndmask_b32 v14, v14, v3, vcc
    v_cndmask_b32 v15, v15, v4, vcc
    v_mov_b32 v104, 0
    v_mov_b32 v105, 0
    v_mov_b32 v106, 0
    v_mov_b32 v107, 0
    v_mov_b32 v108, 0
    v_mov_b32 v109, 0
    v_mov_b32 v110, 0
    v_mov_b32 v111, 0
    v_mov_b32 v112, 0
    v_mov_b32 v113, 0
    v_mov_b32 v114, 0
    v_mov_b32 v115, 0
    v_mov_b32 v116, 0
    v_mov_b32 v117, 0
    v_mov_b32 v118, 0
    v_mov_b32 v119, 0
    s_add_u32 s21, s19, 2097152
    s_add_u32 s22, s19, 4194304
    s_mov_b32 s23, 0
L_1015:
    buffer_load_dwordx4 v[152:155], v1, s[4:7], s21 offen offset:0
    buffer_load_dwordx4 v[156:159], v1, s[4:7], s21 offen offset:1024
    buffer_load_dwordx4 v[184:187], v1, s[4:7], s22 offen offset:0
    buffer_load_dwordx4 v[188:191], v1, s[4:7], s22 offen offset:1024
    s_waitcnt vmcnt(0)
    v_mfma_f32_32x32x16_bf16 v[40:55], v[152:155], v[8:11], 0
    v_mfma_f32_32x32x16_bf16 v[40:55], v[156:159], v[12:15], v[40:55]
    s_nop 7
    s_nop 7
    v_exp_f32 v40, v40
    v_exp_f32 v41, v41
    v_exp_f32 v42, v42
    v_exp_f32 v43, v43
    v_exp_f32 v44, v44
    v_exp_f32 v45, v45
    v_exp_f32 v46, v46
    v_exp_f32 v47, v47
    v_exp_f32 v48, v48
    v_exp_f32 v49, v49
    v_exp_f32 v50, v50
    v_exp_f32 v51, v51
    v_exp_f32 v52, v52
    v_exp_f32 v53, v53
    v_exp_f32 v54, v54
    v_exp_f32 v55, v55
    s_nop 0
    v_cvt_pk_bf16_f32 v136, v40, v41
    v_cvt_pk_bf16_f32 v137, v42, v43
    v_cvt_pk_bf16_f32 v138, v44, v45
    v_cvt_pk_bf16_f32 v139, v46, v47
    v_cvt_pk_bf16_f32 v140, v48, v49
    v_cvt_pk_bf16_f32 v141, v50, v51
    v_cvt_pk_bf16_f32 v142, v52, v53
    v_cvt_pk_bf16_f32 v143, v54, v55
    s_nop 1
    v_mfma_f32_32x32x16_bf16 v[104:119], v[184:187], v[136:139], v[104:119]
    v_mfma_f32_32x32x16_bf16 v[104:119], v[188:191], v[140:143], v[104:119]
    s_add_u32 s21, s21, 2048
    s_add_u32 s22, s22, 2048
    s_add_u32 s23, s23, 1
    s_cmp_lt_u32 s23, 64
    s_cbranch_scc1 L_1015
    s_nop 7
    s_nop 7
    v_mov_b32 v8, v116
    v_mov_b32 v9, v116
    s_nop 1
    v_permlane32_swap_b32 v8, v9
    s_nop 1
    s_branch FIN_1012
R_1002:
    s_sub_u32 s2, s2, 256
    s_load_dwordx2 s[8:9], s[0:1], 104
    s_load_dwordx2 s[30:31], s[0:1], 48
    s_and_b32 s3, s2, 7
    s_mul_i32 s3, s3, 28
    s_lshr_b32 s2, s2, 3
    s_add_u32 s32, s3, s2
    s_lshl_b32 s33, s32, 2
    v_lshrrev_b32 v2, 6, v0
    v_and_b32 v1, 63, v0
    v_readfirstlane_b32 s34, v2
    v_lshlrev_b32 v4, 4, v0
    v_add_u32 v5, 16, v4
    v_cmp_eq_u32 vcc, 255, v0
    v_mov_b32 v6, 16777216
    v_cndmask_b32 v5, v5, v6, vcc
    s_waitcnt lgkmcnt(0)
    s_mov_b32 s10, 0x1000000
    s_mov_b32 s11, 0x20000
    s_load_dword s36, s[30:31], s33
    s_lshl_b32 s3, s32, 13
    s_add_u32 s44, s3, 13631488
    s_add_u32 s45, s3, 13635584
    s_add_u32 s46, s3, 11534336
    s_add_u32 s47, s3, 11538432
    buffer_load_dwordx4 v[56:59], v4, s[8:11], s44 offen
    buffer_load_dwordx4 v[60:63], v5, s[8:11], s44 offen
    buffer_load_dwordx4 v[64:67], v4, s[8:11], s45 offen
    buffer_load_dwordx4 v[68:71], v5, s[8:11], s45 offen
    buffer_load_dwordx4 v[16:19], v4, s[8:11], s46 offen
    buffer_load_dwordx4 v[20:23], v4, s[8:11], s47 offen
    v_mov_b32 v24, 0
    v_mov_b32 v25, 0
    v_mov_b32 v26, 0
    v_mov_b32 v27, 0
    v_add_u32 v7, 67072, v4
    ds_write_b128 v7, v[24:27]
    v_and_b32 v5, 7, v0
    v_mul_u32_u24 v51, 4192, v5
    v_lshrrev_b32 v5, 3, v0
    v_lshl_add_u32 v51, v5, 4, v51
    v_cmp_gt_u32 vcc, 32, v0
    s_and_saveexec_b64 s[38:39], vcc
    ds_write_b128 v7, v[24:27] offset:4096
    ds_write_b128 v51, v[24:27] offset:4096
    ds_write_b128 v51, v[24:27] offset:37632
    s_mov_b64 exec, s[38:39]
    s_lshr_b32 s44, s34, 1
    s_and_b32 s45, s34, 1
    v_and_b32 v5, 31, v1
    v_lshrrev_b32 v6, 5, v1
    v_and_b32 v7, 7, v5
    v_sub_u32 v7, 7, v7
    v_mul_u32_u24 v43, 4192, v7
    v_lshrrev_b32 v7, 3, v5
    v_sub_u32 v7, v6, v7
    v_lshlrev_b32 v7, 4, v7
    v_add_u32 v43, v43, v7
    s_lshl_b32 s46, s34, 9
    s_sub_u32 s46, 1584, s46
    v_add_u32 v43, s46, v43
    v_mul_u32_u24 v44, 144, v5
    v_lshl_add_u32 v44, v6, 4, v44
    s_mul_i32 s46, s34, 1152
    s_sub_u32 s46, 70672, s46
    v_add_u32 v44, s46, v44
    v_lshlrev_b32 v45, 4, v1
    s_lshl_b32 s46, s34, 13
    v_add_u32 v45, s46, v45
    v_lshlrev_b32 v46, 4, v1
    s_lshl_b32 s46, s34, 11
    v_add_u32 v46, s46, v46
    s_lshl_b32 s46, s44, 5
    s_add_u32 s46, s46, 32
    v_add_u32 v7, s46, v5
    v_mul_u32_u24 v47, 144, v7
    v_lshl_add_u32 v47, v6, 3, v47
    s_lshl_b32 s46, s45, 5
    s_add_u32 s46, s46, 67072
    v_add_u32 v47, s46, v47
    v_lshlrev_b32 v48, 6, v5
    v_lshl_add_u32 v48, v6, 4, v48
    s_lshl_b32 s46, s44, 11
    s_lshl_b32 s47, s45, 5
    s_add_u32 s46, s46, s47
    v_add_u32 v48, s46, v48
    v_lshrrev_b32 v5, 2, v0
    v_mul_u32_u24 v5, 144, v5
    v_and_b32 v6, 3, v0
    v_lshl_add_u32 v5, v6, 4, v5
    v_add_u32 v49, 71680, v5
    s_waitcnt vmcnt(4)
    ds_write_b128 v4, v[56:59] offset:0
    v_alignbyte_b32 v72, v57, v56, 2
    v_alignbyte_b32 v73, v58, v57, 2
    v_alignbyte_b32 v74, v59, v58, 2
    v_alignbyte_b32 v75, v60, v59, 2
    v_alignbyte_b32 v76, v61, v60, 2
    v_alignbyte_b32 v77, v62, v61, 2
    ds_write_b128 v4, v[72:75] offset:4192
    ds_write_b128 v4, v[74:77] offset:20960
    ds_write_b128 v4, v[58:61] offset:16768
    v_alignbyte_b32 v80, v58, v57, 2
    v_alignbyte_b32 v81, v59, v58, 2
    v_alignbyte_b32 v82, v60, v59, 2
    v_alignbyte_b32 v83, v61, v60, 2
    v_alignbyte_b32 v84, v62, v61, 2
    v_alignbyte_b32 v85, v63, v62, 2
    ds_write_b128 v4, v[80:83] offset:12576
    ds_write_b128 v4, v[82:85] offset:29344
    v_mov_b32 v88, v57
    v_mov_b32 v89, v58
    v_mov_b32 v90, v59
    v_mov_b32 v91, v60
    v_mov_b32 v92, v61
    v_mov_b32 v93, v62
    ds_write_b128 v4, v[88:91] offset:8384
    ds_write_b128 v4, v[90:93] offset:25152
    s_waitcnt vmcnt(2)
    ds_write_b128 v4, v[64:67] offset:33536
    v_alignbyte_b32 v96, v65, v64, 2
    v_alignbyte_b32 v97, v66, v65, 2
    v_alignbyte_b32 v98, v67, v66, 2
    v_alignbyte_b32 v99, v68, v67, 2
    v_alignbyte_b32 v100, v69, v68, 2
    v_alignbyte_b32 v101, v70, v69, 2
    ds_write_b128 v4, v[96:99] offset:37728
    ds_write_b128 v4, v[98:101] offset:54496
    ds_write_b128 v4, v[66:69] offset:50304
    v_alignbyte_b32 v104, v66, v65, 2
    v_alignbyte_b32 v105, v67, v66, 2
    v_alignbyte_b32 v106, v68, v67, 2
    v_alignbyte_b32 v107, v69, v68, 2
    v_alignbyte_b32 v108, v70, v69, 2
    v_alignbyte_b32 v109, v71, v70, 2
    ds_write_b128 v4, v[104:107] offset:46112
    ds_write_b128 v4, v[106:109] offset:62880
    v_mov_b32 v112, v65
    v_mov_b32 v113, v66
    v_mov_b32 v114, v67
    v_mov_b32 v115, v68
    v_mov_b32 v116, v69
    v_mov_b32 v117, v70
    ds_write_b128 v4, v[112:115] offset:41920
    ds_write_b128 v4, v[114:117] offset:58688
    s_waitcnt vmcnt(1)
    ds_write_b128 v49, v[16:19]
    s_waitcnt vmcnt(0)
    ds_write_b128 v49, v[20:23] offset:64
    s_waitcnt lgkmcnt(0)
    s_lshl_b32 s50, s36, 16
    s_and_b32 s51, s36, 0xffff0000
    s_barrier
    ds_read_b128 v[56:59], v43 offset:2496
    ds_read_b128 v[60:63], v44 offset:1008
    ds_read_b128 v[64:67], v43 offset:448
    ds_read_b128 v[68:71], v44 offset:5616
    ds_read_b128 v[72:75], v43 offset:2528
    ds_read_b128 v[76:79], v44 offset:1040
    ds_read_b128 v[80:83], v43 offset:480
    ds_read_b128 v[84:87], v44 offset:5648
    s_waitcnt lgkmcnt(4)
    v_mfma_f32_32x32x16_bf16 v[96:111], v[56:59], v[60:63], 0
    v_mfma_f32_32x32x16_bf16 v[112:127], v[64:67], v[60:63], 0
    v_mfma_f32_32x32x16_bf16 v[112:127], v[56:59], v[68:71], v[112:127]
    ds_read_b128 v[56:59], v43 offset:2432
    ds_read_b128 v[60:63], v44 offset:864
    ds_read_b128 v[64:67], v43 offset:384
    ds_read_b128 v[68:71], v44 offset:5472
    s_waitcnt lgkmcnt(4)
    v_mfma_f32_32x32x16_bf16 v[96:111], v[72:75], v[76:79], v[96:111]
    v_mfma_f32_32x32x16_bf16 v[112:127], v[80:83], v[76:79], v[112:127]
    v_mfma_f32_32x32x16_bf16 v[112:127], v[72:75], v[84:87], v[112:127]
    ds_read_b128 v[72:75], v43 offset:2464
    ds_read_b128 v[76:79], v44 offset:896
    ds_read_b128 v[80:83], v43 offset:416
    ds_read_b128 v[84:87], v44 offset:5504
    s_waitcnt lgkmcnt(4)
    v_mfma_f32_32x32x16_bf16 v[96:111], v[56:59], v[60:63], v[96:111]
    v_mfma_f32_32x32x16_bf16 v[112:127], v[64:67], v[60:63], v[112:127]
    v_mfma_f32_32x32x16_bf16 v[112:127], v[56:59], v[68:71], v[112:127]
    ds_read_b128 v[56:59], v43 offset:2368
    ds_read_b128 v[60:63], v44 offset:720
    ds_read_b128 v[64:67], v43 offset:320
    ds_read_b128 v[68:71], v44 offset:5328
    s_waitcnt lgkmcnt(4)
    v_mfma_f32_32x32x16_bf16 v[96:111], v[72:75], v[76:79], v[96:111]
    v_mfma_f32_32x32x16_bf16 v[112:127], v[80:83], v[76:79], v[112:127]
    v_mfma_f32_32x32x16_bf16 v[112:127], v[72:75], v[84:87], v[112:127]
    ds_read_b128 v[72:75], v43 offset:2400
    ds_read_b128 v[76:79], v44 offset:752
    ds_read_b128 v[80:83], v43 offset:352
    ds_read_b128 v[84:87], v44 offset:5360
    s_waitcnt lgkmcnt(4)
    v_mfma_f32_32x32x16_bf16 v[96:111], v[56:59], v[60:63], v[96:111]
    v_mfma_f32_32x32x16_bf16 v[112:127], v[64:67], v[60:63], v[112:127]
    v_mfma_f32_32x32x16_bf16 v[112:127], v[56:59], v[68:71], v[112:127]
    ds_read_b128 v[56:59], v43 offset:2304
    ds_read_b128 v[60:63], v44 offset:576
    ds_read_b128 v[64:67], v43 offset:256
    ds_read_b128 v[68:71], v44 offset:5184
    s_waitcnt lgkmcnt(4)
    v_mfma_f32_32x32x16_bf16 v[96:111], v[72:75], v[76:79], v[96:111]
    v_mfma_f32_32x32x16_bf16 v[112:127], v[80:83], v[76:79], v[112:127]
    v_mfma_f32_32x32x16_bf16 v[112:127], v[72:75], v[84:87], v[112:127]
    ds_read_b128 v[72:75], v43 offset:2336
    ds_read_b128 v[76:79], v44 offset:608
    ds_read_b128 v[80:83], v43 offset:288
    ds_read_b128 v[84:87], v44 offset:5216
    s_waitcnt lgkmcnt(4)
    v_mfma_f32_32x32x16_bf16 v[96:111], v[56:59], v[60:63], v[96:111]
    v_mfma_f32_32x32x16_bf16 v[112:127], v[64:67], v[60:63], v[112:127]
    v_mfma_f32_32x32x16_bf16 v[112:127], v[56:59], v[68:71], v[112:127]
    ds_read_b128 v[56:59], v43 offset:2240
    ds_read_b128 v[60:63], v44 offset:432
    ds_read_b128 v[64:67], v43 offset:192
    ds_read_b128 v[68:71], v44 offset:5040
    s_waitcnt lgkmcnt(4)
    v_mfma_f32_32x32x16_bf16 v[96:111], v[72:75], v[76:79], v[96:111]
    v_mfma_f32_32x32x16_bf16 v[112:127], v[80:83], v[76:79], v[112:127]
    v_mfma_f32_32x32x16_bf16 v[112:127], v[72:75], v[84:87], v[112:127]
    ds_read_b128 v[72:75], v43 offset:2272
    ds_read_b128 v[76:79], v44 offset:464
    ds_read_b128 v[80:83], v43 offset:224
    ds_read_b128 v[84:87], v44 offset:5072
    s_waitcnt lgkmcnt(4)
    v_mfma_f32_32x32x16_bf16 v[96:111], v[56:59], v[60:63], v[96:111]
    v_mfma_f32_32x32x16_bf16 v[112:127], v[64:67], v[60:63], v[112:127]
    v_mfma_f32_32x32x16_bf16 v[112:127], v[56:59], v[68:71], v[112:127]
    ds_read_b128 v[56:59], v43 offset:2176
    ds_read_b128 v[60:63], v44 offset:288
    ds_read_b128 v[64:67], v43 offset:128
    ds_read_b128 v[68:71], v44 offset:4896
    s_waitcnt lgkmcnt(4)
    v_mfma_f32_32x32x16_bf16 v[96:111], v[72:75], v[76:79], v[96:111]
    v_mfma_f32_32x32x16_bf16 v[112:127], v[80:83], v[76:79], v[112:127]
    v_mfma_f32_32x32x16_bf16 v[112:127], v[72:75], v[84:87], v[112:127]
    ds_read_b128 v[72:75], v43 offset:2208
    ds_read_b128 v[76:79], v44 offset:320
    ds_read_b128 v[80:83], v43 offset:160
    ds_read_b128 v[84:87], v44 offset:4928
    s_waitcnt lgkmcnt(4)
    v_mfma_f32_32x32x16_bf16 v[96:111], v[56:59], v[60:63], v[96:111]
    v_mfma_f32_32x32x16_bf16 v[112:127], v[64:67], v[60:63], v[112:127]
    v_mfma_f32_32x32x16_bf16 v[112:127], v[56:59], v[68:71], v[112:127]
    ds_read_b128 v[56:59], v43 offset:2112
    ds_read_b128 v[60:63], v44 offset:144
    ds_read_b128 v[64:67], v43 offset:64
    ds_read_b128 v[68:71], v44 offset:4752
    s_waitcnt lgkmcnt(4)
    v_mfma_f32_32x32x16_bf16 v[96:111], v[72:75], v[76:79], v[96:111]
    v_mfma_f32_32x32x16_bf16 v[112:127], v[80:83], v[76:79], v[112:127]
    v_mfma_f32_32x32x16_bf16 v[112:127], v[72:75], v[84:87], v[112:127]
    ds_read_b128 v[72:75], v43 offset:2144
    ds_read_b128 v[76:79], v44 offset:176
    ds_read_b128 v[80:83], v43 offset:96
    ds_read_b128 v[84:87], v44 offset:4784
    s_waitcnt lgkmcnt(4)
    v_mfma_f32_32x32x16_bf16 v[96:111], v[56:59], v[60:63], v[96:111]
    v_mfma_f32_32x32x16_bf16 v[112:127], v[64:67], v[60:63], v[112:127]
    v_mfma_f32_32x32x16_bf16 v[112:127], v[56:59], v[68:71], v[112:127]
    ds_read_b128 v[56:59], v43 offset:2048
    ds_read_b128 v[60:63], v44 offset:0
    ds_read_b128 v[64:67], v43 offset:0
    ds_read_b128 v[68:71], v44 offset:4608
    s_waitcnt lgkmcnt(4)
    v_mfma_f32_32x32x16_bf16 v[96:111], v[72:75], v[76:79], v[96:111]
    v_mfma_f32_32x32x16_bf16 v[112:127], v[80:83], v[76:79], v[112:127]
    v_mfma_f32_32x32x16_bf16 v[112:127], v[72:75], v[84:87], v[112:127]
    ds_read_b128 v[72:75], v43 offset:2080
    ds_read_b128 v[76:79], v44 offset:32
    ds_read_b128 v[80:83], v43 offset:32
    ds_read_b128 v[84:87], v44 offset:4640
    s_waitcnt lgkmcnt(4)
    v_mfma_f32_32x32x16_bf16 v[96:111], v[56:59], v[60:63], v[96:111]
    v_mfma_f32_32x32x16_bf16 v[112:127], v[64:67], v[60:63], v[112:127]
    v_mfma_f32_32x32x16_bf16 v[112:127], v[56:59], v[68:71], v[112:127]
    ds_read_b128 v[56:59], v43 offset:36032
    ds_read_b128 v[60:63], v44 offset:1072
    ds_read_b128 v[64:67], v43 offset:33984
    ds_read_b128 v[68:71], v44 offset:5680
    s_waitcnt lgkmcnt(4)
    v_mfma_f32_32x32x16_bf16 v[96:111], v[72:75], v[76:79], v[96:111]
    v_mfma_f32_32x32x16_bf16 v[112:127], v[80:83], v[76:79], v[112:127]
    v_mfma_f32_32x32x16_bf16 v[112:127], v[72:75], v[84:87], v[112:127]
    ds_read_b128 v[72:75], v43 offset:36064
    ds_read_b128 v[76:79], v44 offset:1104
    ds_read_b128 v[80:83], v43 offset:34016
    ds_read_b128 v[84:87], v44 offset:5712
    s_waitcnt lgkmcnt(4)
    v_mfma_f32_32x32x16_bf16 v[128:143], v[56:59], v[60:63], 0
    v_mfma_f32_32x32x16_bf16 v[144:159], v[64:67], v[60:63], 0
    v_mfma_f32_32x32x16_bf16 v[144:159], v[56:59], v[68:71], v[144:159]
    ds_read_b128 v[56:59], v43 offset:35968
    ds_read_b128 v[60:63], v44 offset:928
    ds_read_b128 v[64:67], v43 offset:33920
    ds_read_b128 v[68:71], v44 offset:5536
    s_waitcnt lgkmcnt(4)
    v_mfma_f32_32x32x16_bf16 v[128:143], v[72:75], v[76:79], v[128:143]
    v_mfma_f32_32x32x16_bf16 v[144:159], v[80:83], v[76:79], v[144:159]
    v_mfma_f32_32x32x16_bf16 v[144:159], v[72:75], v[84:87], v[144:159]
    ds_read_b128 v[72:75], v43 offset:36000
    ds_read_b128 v[76:79], v44 offset:960
    ds_read_b128 v[80:83], v43 offset:33952
    ds_read_b128 v[84:87], v44 offset:5568
    s_waitcnt lgkmcnt(4)
    v_mfma_f32_32x32x16_bf16 v[128:143], v[56:59], v[60:63], v[128:143]
    v_mfma_f32_32x32x16_bf16 v[144:159], v[64:67], v[60:63], v[144:159]
    v_mfma_f32_32x32x16_bf16 v[144:159], v[56:59], v[68:71], v[144:159]
    ds_read_b128 v[56:59], v43 offset:35904
    ds_read_b128 v[60:63], v44 offset:784
    ds_read_b128 v[64:67], v43 offset:33856
    ds_read_b128 v[68:71], v44 offset:5392
    s_waitcnt lgkmcnt(4)
    v_mfma_f32_32x32x16_bf16 v[128:143], v[72:75], v[76:79], v[128:143]
    v_mfma_f32_32x32x16_bf16 v[144:159], v[80:83], v[76:79], v[144:159]
    v_mfma_f32_32x32x16_bf16 v[144:159], v[72:75], v[84:87], v[144:159]
    ds_read_b128 v[72:75], v43 offset:35936
    ds_read_b128 v[76:79], v44 offset:816
    ds_read_b128 v[80:83], v43 offset:33888
    ds_read_b128 v[84:87], v44 offset:5424
    s_waitcnt lgkmcnt(4)
    v_mfma_f32_32x32x16_bf16 v[128:143], v[56:59], v[60:63], v[128:143]
    v_mfma_f32_32x32x16_bf16 v[144:159], v[64:67], v[60:63], v[144:159]
    v_mfma_f32_32x32x16_bf16 v[144:159], v[56:59], v[68:71], v[144:159]
    ds_read_b128 v[56:59], v43 offset:35840
    ds_read_b128 v[60:63], v44 offset:640
    ds_read_b128 v[64:67], v43 offset:33792
    ds_read_b128 v[68:71], v44 offset:5248
    s_waitcnt lgkmcnt(4)
    v_mfma_f32_32x32x16_bf16 v[128:143], v[72:75], v[76:79], v[128:143]
    v_mfma_f32_32x32x16_bf16 v[144:159], v[80:83], v[76:79], v[144:159]
    v_mfma_f32_32x32x16_bf16 v[144:159], v[72:75], v[84:87], v[144:159]
    ds_read_b128 v[72:75], v43 offset:35872
    ds_read_b128 v[76:79], v44 offset:672
    ds_read_b128 v[80:83], v43 offset:33824
    ds_read_b128 v[84:87], v44 offset:5280
    s_waitcnt lgkmcnt(4)
    v_mfma_f32_32x32x16_bf16 v[128:143], v[56:59], v[60:63], v[128:143]
    v_mfma_f32_32x32x16_bf16 v[144:159], v[64:67], v[60:63], v[144:159]
    v_mfma_f32_32x32x16_bf16 v[144:159], v[56:59], v[68:71], v[144:159]
    ds_read_b128 v[56:59], v43 offset:35776
    ds_read_b128 v[60:63], v44 offset:496
    ds_read_b128 v[64:67], v43 offset:33728
    ds_read_b128 v[68:71], v44 offset:5104
    s_waitcnt lgkmcnt(4)
    v_mfma_f32_32x32x16_bf16 v[128:143], v[72:75], v[76:79], v[128:143]
    v_mfma_f32_32x32x16_bf16 v[144:159], v[80:83], v[76:79], v[144:159]
    v_mfma_f32_32x32x16_bf16 v[144:159], v[72:75], v[84:87], v[144:159]
    ds_read_b128 v[72:75], v43 offset:35808
    ds_read_b128 v[76:79], v44 offset:528
    ds_read_b128 v[80:83], v43 offset:33760
    ds_read_b128 v[84:87], v44 offset:5136
    s_waitcnt lgkmcnt(4)
    v_mfma_f32_32x32x16_bf16 v[128:143], v[56:59], v[60:63], v[128:143]
    v_mfma_f32_32x32x16_bf16 v[144:159], v[64:67], v[60:63], v[144:159]
    v_mfma_f32_32x32x16_bf16 v[144:159], v[56:59], v[68:71], v[144:159]
    ds_read_b128 v[56:59], v43 offset:35712
    ds_read_b128 v[60:63], v44 offset:352
    ds_read_b128 v[64:67], v43 offset:33664
    ds_read_b128 v[68:71], v44 offset:4960
    s_waitcnt lgkmcnt(4)
    v_mfma_f32_32x32x16_bf16 v[128:143], v[72:75], v[76:79], v[128:143]
    v_mfma_f32_32x32x16_bf16 v[144:159], v[80:83], v[76:79], v[144:159]
    v_mfma_f32_32x32x16_bf16 v[144:159], v[72:75], v[84:87], v[144:159]
    ds_read_b128 v[72:75], v43 offset:35744
    ds_read_b128 v[76:79], v44 offset:384
    ds_read_b128 v[80:83], v43 offset:33696
    ds_read_b128 v[84:87], v44 offset:4992
    s_waitcnt lgkmcnt(4)
    v_mfma_f32_32x32x16_bf16 v[128:143], v[56:59], v[60:63], v[128:143]
    v_mfma_f32_32x32x16_bf16 v[144:159], v[64:67], v[60:63], v[144:159]
    v_mfma_f32_32x32x16_bf16 v[144:159], v[56:59], v[68:71], v[144:159]
    ds_read_b128 v[56:59], v43 offset:35648
    ds_read_b128 v[60:63], v44 offset:208
    ds_read_b128 v[64:67], v43 offset:33600
    ds_read_b128 v[68:71], v44 offset:4816
    s_waitcnt lgkmcnt(4)
    v_mfma_f32_32x32x16_bf16 v[128:143], v[72:75], v[76:79], v[128:143]
    v_mfma_f32_32x32x16_bf16 v[144:159], v[80:83], v[76:79], v[144:159]
    v_mfma_f32_32x32x16_bf16 v[144:159], v[72:75], v[84:87], v[144:159]
    ds_read_b128 v[72:75], v43 offset:35680
    ds_read_b128 v[76:79], v44 offset:240
    ds_read_b128 v[80:83], v43 offset:33632
    ds_read_b128 v[84:87], v44 offset:4848
    s_waitcnt lgkmcnt(4)
    v_mfma_f32_32x32x16_bf16 v[128:143], v[56:59], v[60:63], v[128:143]
    v_mfma_f32_32x32x16_bf16 v[144:159], v[64:67], v[60:63], v[144:159]
    v_mfma_f32_32x32x16_bf16 v[144:159], v[56:59], v[68:71], v[144:159]
    ds_read_b128 v[56:59], v43 offset:35584
    ds_read_b128 v[60:63], v44 offset:64
    ds_read_b128 v[64:67], v43 offset:33536
    ds_read_b128 v[68:71], v44 offset:4672
    s_waitcnt lgkmcnt(4)
    v_mfma_f32_32x32x16_bf16 v[128:143], v[72:75], v[76:79], v[128:143]
    v_mfma_f32_32x32x16_bf16 v[144:159], v[80:83], v[76:79], v[144:159]
    v_mfma_f32_32x32x16_bf16 v[144:159], v[72:75], v[84:87], v[144:159]
    ds_read_b128 v[72:75], v43 offset:35616
    ds_read_b128 v[76:79], v44 offset:96
    ds_read_b128 v[80:83], v43 offset:33568
    ds_read_b128 v[84:87], v44 offset:4704
    s_waitcnt lgkmcnt(4)
    v_mfma_f32_32x32x16_bf16 v[128:143], v[56:59], v[60:63], v[128:143]
    v_mfma_f32_32x32x16_bf16 v[144:159], v[64:67], v[60:63], v[144:159]
    v_mfma_f32_32x32x16_bf16 v[144:159], v[56:59], v[68:71], v[144:159]
    s_waitcnt lgkmcnt(0)
    v_mfma_f32_32x32x16_bf16 v[128:143], v[72:75], v[76:79], v[128:143]
    v_mfma_f32_32x32x16_bf16 v[144:159], v[80:83], v[76:79], v[144:159]
    v_mfma_f32_32x32x16_bf16 v[144:159], v[72:75], v[84:87], v[144:159]
    s_barrier
    s_nop 7
    s_nop 3
    ds_write_b128 v45, v[96:99] offset:0
    ds_write_b128 v45, v[100:103] offset:1024
    ds_write_b128 v45, v[104:107] offset:2048
    ds_write_b128 v45, v[108:111] offset:3072
    ds_write_b128 v45, v[112:115] offset:4096
    ds_write_b128 v45, v[116:119] offset:5120
    ds_write_b128 v45, v[120:123] offset:6144
    ds_write_b128 v45, v[124:127] offset:7168
    ds_write_b128 v45, v[128:131] offset:32768
    ds_write_b128 v45, v[132:135] offset:33792
    ds_write_b128 v45, v[136:139] offset:34816
    ds_write_b128 v45, v[140:143] offset:35840
    ds_write_b128 v45, v[144:147] offset:36864
    ds_write_b128 v45, v[148:151] offset:37888
    ds_write_b128 v45, v[152:155] offset:38912
    ds_write_b128 v45, v[156:159] offset:39936
    s_waitcnt lgkmcnt(0)
    s_barrier
    ds_read_b128 v[56:59], v46 offset:0
    ds_read_b128 v[60:63], v46 offset:8192
    ds_read_b128 v[64:67], v46 offset:16384
    ds_read_b128 v[68:71], v46 offset:24576
    ds_read_b64 v[88:89], v47 offset:0
    ds_read_b128 v[72:75], v46 offset:1024
    ds_read_b128 v[76:79], v46 offset:9216
    ds_read_b128 v[80:83], v46 offset:17408
    ds_read_b128 v[84:87], v46 offset:25600
    ds_read_b64 v[90:91], v47 offset:16
    s_mul_i32 s46, s32, 8192
    s_add_u32 s46, s46, 9437184
    s_waitcnt lgkmcnt(5)
    ds_read_b128 v[96:99], v46 offset:32768
    ds_read_b128 v[100:103], v46 offset:40960
    ds_read_b128 v[104:107], v46 offset:49152
    ds_read_b128 v[108:111], v46 offset:57344
    ds_read_b64 v[92:93], v47 offset:64
    ds_read_b128 v[112:115], v46 offset:33792
    ds_read_b128 v[116:119], v46 offset:41984
    ds_read_b128 v[120:123], v46 offset:50176
    ds_read_b128 v[124:127], v46 offset:58368
    ds_read_b64 v[94:95], v47 offset:80
    v_add_f32 v56, v56, v60
    v_add_f32 v64, v64, v68
    v_add_f32 v57, v57, v61
    v_add_f32 v65, v65, v69
    v_add_f32 v58, v58, v62
    v_add_f32 v66, v66, v70
    v_add_f32 v59, v59, v63
    v_add_f32 v67, v67, v71
    v_add_f32 v56, v56, v64
    v_add_f32 v57, v57, v65
    v_add_f32 v58, v58, v66
    v_add_f32 v59, v59, v67
    v_cvt_pk_bf16_f32 v56, v56, v57
    v_cvt_pk_bf16_f32 v58, v58, v59
    v_lshlrev_b32 v60, 16, v88
    v_and_b32 v61, 0xffff0000, v88
    v_lshlrev_b32 v62, 16, v89
    v_and_b32 v63, 0xffff0000, v89
    v_mul_f32 v60, s50, v60
    v_mul_f32 v61, s50, v61
    v_mul_f32 v62, s50, v62
    v_mul_f32 v63, s50, v63
    v_cvt_pk_bf16_f32 v60, v60, v61
    v_cvt_pk_bf16_f32 v62, v62, v63
    v_lshlrev_b32 v64, 16, v56
    v_and_b32 v65, 0xffff0000, v56
    v_lshlrev_b32 v66, 16, v58
    v_and_b32 v67, 0xffff0000, v58
    v_lshlrev_b32 v68, 16, v60
    v_and_b32 v69, 0xffff0000, v60
    v_lshlrev_b32 v70, 16, v62
    v_and_b32 v71, 0xffff0000, v62
    v_add_f32 v64, v64, v68
    v_add_f32 v65, v65, v69
    v_add_f32 v66, v66, v70
    v_add_f32 v67, v67, v71
    v_cvt_pk_bf16_f32 v56, v64, v65
    v_cvt_pk_bf16_f32 v57, v66, v67
    s_waitcnt lgkmcnt(10)
    v_add_f32 v72, v72, v76
    v_add_f32 v80, v80, v84
    v_add_f32 v73, v73, v77
    v_add_f32 v81, v81, v85
    v_add_f32 v74, v74, v78
    v_add_f32 v82, v82, v86
    v_add_f32 v75, v75, v79
    v_add_f32 v83, v83, v87
    v_add_f32 v72, v72, v80
    v_add_f32 v73, v73, v81
    v_add_f32 v74, v74, v82
    v_add_f32 v75, v75, v83
    v_cvt_pk_bf16_f32 v72, v72, v73
    v_cvt_pk_bf16_f32 v74, v74, v75
    v_lshlrev_b32 v76, 16, v90
    v_and_b32 v77, 0xffff0000, v90
    v_lshlrev_b32 v78, 16, v91
    v_and_b32 v79, 0xffff0000, v91
    v_mul_f32 v76, s50, v76
    v_mul_f32 v77, s50, v77
    v_mul_f32 v78, s50, v78
    v_mul_f32 v79, s50, v79
    v_cvt_pk_bf16_f32 v76, v76, v77
    v_cvt_pk_bf16_f32 v78, v78, v79
    v_lshlrev_b32 v80, 16, v72
    v_and_b32 v81, 0xffff0000, v72
    v_lshlrev_b32 v82, 16, v74
    v_and_b32 v83, 0xffff0000, v74
    v_lshlrev_b32 v84, 16, v76
    v_and_b32 v85, 0xffff0000, v76
    v_lshlrev_b32 v86, 16, v78
    v_and_b32 v87, 0xffff0000, v78
    v_add_f32 v80, v80, v84
    v_add_f32 v81, v81, v85
    v_add_f32 v82, v82, v86
    v_add_f32 v83, v83, v87
    v_cvt_pk_bf16_f32 v58, v80, v81
    v_cvt_pk_bf16_f32 v59, v82, v83
    s_nop 1
    v_permlane32_swap_b32 v56, v58
    v_permlane32_swap_b32 v57, v59
    s_nop 1
    buffer_store_dwordx4 v[56:59], v48, s[8:11], s46 offen sc1
    s_mul_i32 s46, s32, 8192
    s_add_u32 s46, s46, 9441280
    s_waitcnt lgkmcnt(5)
    v_add_f32 v96, v96, v100
    v_add_f32 v104, v104, v108
    v_add_f32 v97, v97, v101
    v_add_f32 v105, v105, v109
    v_add_f32 v98, v98, v102
    v_add_f32 v106, v106, v110
    v_add_f32 v99, v99, v103
    v_add_f32 v107, v107, v111
    v_add_f32 v96, v96, v104
    v_add_f32 v97, v97, v105
    v_add_f32 v98, v98, v106
    v_add_f32 v99, v99, v107
    v_cvt_pk_bf16_f32 v96, v96, v97
    v_cvt_pk_bf16_f32 v98, v98, v99
    v_lshlrev_b32 v100, 16, v92
    v_and_b32 v101, 0xffff0000, v92
    v_lshlrev_b32 v102, 16, v93
    v_and_b32 v103, 0xffff0000, v93
    v_mul_f32 v100, s51, v100
    v_mul_f32 v101, s51, v101
    v_mul_f32 v102, s51, v102
    v_mul_f32 v103, s51, v103
    v_cvt_pk_bf16_f32 v100, v100, v101
    v_cvt_pk_bf16_f32 v102, v102, v103
    v_lshlrev_b32 v104, 16, v96
    v_and_b32 v105, 0xffff0000, v96
    v_lshlrev_b32 v106, 16, v98
    v_and_b32 v107, 0xffff0000, v98
    v_lshlrev_b32 v108, 16, v100
    v_and_b32 v109, 0xffff0000, v100
    v_lshlrev_b32 v110, 16, v102
    v_and_b32 v111, 0xffff0000, v102
    v_add_f32 v104, v104, v108
    v_add_f32 v105, v105, v109
    v_add_f32 v106, v106, v110
    v_add_f32 v107, v107, v111
    v_cvt_pk_bf16_f32 v96, v104, v105
    v_cvt_pk_bf16_f32 v97, v106, v107
    s_waitcnt lgkmcnt(0)
    v_add_f32 v112, v112, v116
    v_add_f32 v120, v120, v124
    v_add_f32 v113, v113, v117
    v_add_f32 v121, v121, v125
    v_add_f32 v114, v114, v118
    v_add_f32 v122, v122, v126
    v_add_f32 v115, v115, v119
    v_add_f32 v123, v123, v127
    v_add_f32 v112, v112, v120
    v_add_f32 v113, v113, v121
    v_add_f32 v114, v114, v122
    v_add_f32 v115, v115, v123
    v_cvt_pk_bf16_f32 v112, v112, v113
    v_cvt_pk_bf16_f32 v114, v114, v115
    v_lshlrev_b32 v116, 16, v94
    v_and_b32 v117, 0xffff0000, v94
    v_lshlrev_b32 v118, 16, v95
    v_and_b32 v119, 0xffff0000, v95
    v_mul_f32 v116, s51, v116
    v_mul_f32 v117, s51, v117
    v_mul_f32 v118, s51, v118
    v_mul_f32 v119, s51, v119
    v_cvt_pk_bf16_f32 v116, v116, v117
    v_cvt_pk_bf16_f32 v118, v118, v119
    v_lshlrev_b32 v120, 16, v112
    v_and_b32 v121, 0xffff0000, v112
    v_lshlrev_b32 v122, 16, v114
    v_and_b32 v123, 0xffff0000, v114
    v_lshlrev_b32 v124, 16, v116
    v_and_b32 v125, 0xffff0000, v116
    v_lshlrev_b32 v126, 16, v118
    v_and_b32 v127, 0xffff0000, v118
    v_add_f32 v120, v120, v124
    v_add_f32 v121, v121, v125
    v_add_f32 v122, v122, v126
    v_add_f32 v123, v123, v127
    v_cvt_pk_bf16_f32 v98, v120, v121
    v_cvt_pk_bf16_f32 v99, v122, v123
    s_nop 1
    v_permlane32_swap_b32 v96, v98
    v_permlane32_swap_b32 v97, v99
    s_nop 1
    buffer_store_dwordx4 v[96:99], v48, s[8:11], s46 offen sc1
    s_endpgm
.globl gm_kc_kernel
.p2align 8
.type gm_kc_kernel,@function
gm_kc_kernel:
    s_cmp_lt_u32 s2, 224
    s_cbranch_scc1 R_2001
    s_endpgm
R_2001:
    s_load_dwordx2 s[4:5], s[0:1], 104
    s_load_dwordx2 s[8:9], s[0:1], 88
    s_and_b32 s3, s2, 7
    s_lshl_b32 s3, s3, 2
    s_lshr_b32 s12, s2, 3
    s_and_b32 s13, s12, 3
    s_add_u32 s16, s3, s13
    s_lshr_b32 s17, s12, 2
    v_lshrrev_b32 v1, 6, v0
    v_and_b32 v0, 63, v0
    v_readfirstlane_b32 s18, v1
    v_lshlrev_b32 v1, 4, v0
    s_waitcnt lgkmcnt(0)
    s_mov_b32 s6, 0x1000000
    s_mov_b32 s7, 0x20000
    s_mov_b32 s10, 0x1c0000
    s_mov_b32 s11, 0x20000
    s_lshl_b32 s19, s17, 1
    s_add_u32 s19, s19, s18
    s_lshl_b32 s19, s19, 15
    s_add_u32 s19, s19, 8388608
    s_lshl_b32 s20, s16, 1
    s_add_u32 s20, s20, s18
    s_sub_u32 s20, s20, 2
    s_lshl_b32 s20, s20, 15
    s_add_u32 s20, s20, 6291456
    s_cmp_lt_u32 s18, 2
    s_cselect_b32 s19, s19, s20
    s_lshl_b32 s21, s18, 15
    s_and_b32 s22, s18, 1
    s_lshr_b32 s23, s18, 1
    v_and_b32 v2, 31, v0
    v_lshrrev_b32 v3, 5, v0
    v_lshlrev_b32 v4, 1, v2
    v_lshl_add_u32 v4, v3, 14, v4
    s_lshl_b32 s24, s16, 1
    s_add_u32 s24, s24, s22
    s_lshl_b32 s25, s17, 1
    s_add_u32 s25, s25, s23
    s_lshl_b32 s26, s25, 17
    s_lshl_b32 s27, s24, 6
    s_add_u32 s26, s26, s27
    s_add_u32 s26, s26, 9437184
    v_lshlrev_b32 v5, 2, v2
    s_lshl_b32 s27, s24, 7
    s_add_u32 s27, s27, 8912896
    buffer_load_dword v6, v5, s[4:7], s27 offen
    s_add_u32 s28, s26, 0
    buffer_load_ushort v16, v4, s[4:7], s28 offen
    s_add_u32 s28, s26, 4096
    buffer_load_ushort v17, v4, s[4:7], s28 offen
    s_add_u32 s28, s26, 8192
    buffer_load_ushort v18, v4, s[4:7], s28 offen
    s_add_u32 s28, s26, 12288
    buffer_load_ushort v19, v4, s[4:7], s28 offen
    s_add_u32 s28, s26, 32768
    buffer_load_ushort v20, v4, s[4:7], s28 offen
    s_add_u32 s28, s26, 36864
    buffer_load_ushort v21, v4, s[4:7], s28 offen
    s_add_u32 s28, s26, 40960
    buffer_load_ushort v22, v4, s[4:7], s28 offen
    s_add_u32 s28, s26, 45056
    buffer_load_ushort v23, v4, s[4:7], s28 offen
    s_add_u32 s28, s26, 65536
    buffer_load_ushort v24, v4, s[4:7], s28 offen
    s_add_u32 s28, s26, 69632
    buffer_load_ushort v25, v4, s[4:7], s28 offen
    s_add_u32 s28, s26, 73728
    buffer_load_ushort v26, v4, s[4:7], s28 offen
    s_add_u32 s28, s26, 77824
    buffer_load_ushort v27, v4, s[4:7], s28 offen
    s_add_u32 s28, s26, 98304
    buffer_load_ushort v28, v4, s[4:7], s28 offen
    s_add_u32 s28, s26, 102400
    buffer_load_ushort v29, v4, s[4:7], s28 offen
    s_add_u32 s28, s26, 106496
    buffer_load_ushort v30, v4, s[4:7], s28 offen
    s_add_u32 s28, s26, 110592
    buffer_load_ushort v31, v4, s[4:7], s28 offen
    s_add_u32 s28, s19, 0
    s_add_u32 m0, s21, 0
    s_nop 0
    buffer_load_dwordx4 v1, s[4:7], s28 offen lds
    s_add_u32 s28, s19, 1024
    s_add_u32 m0, s21, 1024
    s_nop 0
    buffer_load_dwordx4 v1, s[4:7], s28 offen lds
    s_add_u32 s28, s19, 2048
    s_add_u32 m0, s21, 2048
    s_nop 0
    buffer_load_dwordx4 v1, s[4:7], s28 offen lds
    s_add_u32 s28, s19, 3072
    s_add_u32 m0, s21, 3072
    s_nop 0
    buffer_load_dwordx4 v1, s[4:7], s28 offen lds
    s_add_u32 s28, s19, 4096
    s_add_u32 m0, s21, 4096
    s_nop 0
    buffer_load_dwordx4 v1, s[4:7], s28 offen lds
    s_add_u32 s28, s19, 5120
    s_add_u32 m0, s21, 5120
    s_nop 0
    buffer_load_dwordx4 v1, s[4:7], s28 offen lds
    s_add_u32 s28, s19, 6144
    s_add_u32 m0, s21, 6144
    s_nop 0
    buffer_load_dwordx4 v1, s[4:7], s28 offen lds
    s_add_u32 s28, s19, 7168
    s_add_u32 m0, s21, 7168
    s_nop 0
    buffer_load_dwordx4 v1, s[4:7], s28 offen lds
    s_add_u32 s28, s19, 8192
    s_add_u32 m0, s21, 8192
    s_nop 0
    buffer_load_dwordx4 v1, s[4:7], s28 offen lds
    s_add_u32 s28, s19, 9216
    s_add_u32 m0, s21, 9216
    s_nop 0
    buffer_load_dwordx4 v1, s[4:7], s28 offen lds
    s_add_u32 s28, s19, 10240
    s_add_u32 m0, s21, 10240
    s_nop 0
    buffer_load_dwordx4 v1, s[4:7], s28 offen lds
    s_add_u32 s28, s19, 11264
    s_add_u32 m0, s21, 11264
    s_nop 0
    buffer_load_dwordx4 v1, s[4:7], s28 offen lds
    s_add_u32 s28, s19, 12288
    s_add_u32 m0, s21, 12288
    s_nop 0
    buffer_load_dwordx4 v1, s[4:7], s28 offen lds
    s_add_u32 s28, s19, 13312
    s_add_u32 m0, s21, 13312
    s_nop 0
    buffer_load_dwordx4 v1, s[4:7], s28 offen lds
    s_add_u32 s28, s19, 14336
    s_add_u32 m0, s21, 14336
    s_nop 0
    buffer_load_dwordx4 v1, s[4:7], s28 offen lds
    s_add_u32 s28, s19, 15360
    s_add_u32 m0, s21, 15360
    s_nop 0
    buffer_load_dwordx4 v1, s[4:7], s28 offen lds
    s_add_u32 s28, s19, 16384
    s_add_u32 m0, s21, 16384
    s_nop 0
    buffer_load_dwordx4 v1, s[4:7], s28 offen lds
    s_add_u32 s28, s19, 17408
    s_add_u32 m0, s21, 17408
    s_nop 0
    buffer_load_dwordx4 v1, s[4:7], s28 offen lds
    s_add_u32 s28, s19, 18432
    s_add_u32 m0, s21, 18432
    s_nop 0
    buffer_load_dwordx4 v1, s[4:7], s28 offen lds
    s_add_u32 s28, s19, 19456
    s_add_u32 m0, s21, 19456
    s_nop 0
    buffer_load_dwordx4 v1, s[4:7], s28 offen lds
    s_add_u32 s28, s19, 20480
    s_add_u32 m0, s21, 20480
    s_nop 0
    buffer_load_dwordx4 v1, s[4:7], s28 offen lds
    s_add_u32 s28, s19, 21504
    s_add_u32 m0, s21, 21504
    s_nop 0
    buffer_load_dwordx4 v1, s[4:7], s28 offen lds
    s_add_u32 s28, s19, 22528
    s_add_u32 m0, s21, 22528
    s_nop 0
    buffer_load_dwordx4 v1, s[4:7], s28 offen lds
    s_add_u32 s28, s19, 23552
    s_add_u32 m0, s21, 23552
    s_nop 0
    buffer_load_dwordx4 v1, s[4:7], s28 offen lds
    s_add_u32 s28, s19, 24576
    s_add_u32 m0, s21, 24576
    s_nop 0
    buffer_load_dwordx4 v1, s[4:7], s28 offen lds
    s_add_u32 s28, s19, 25600
    s_add_u32 m0, s21, 25600
    s_nop 0
    buffer_load_dwordx4 v1, s[4:7], s28 offen lds
    s_add_u32 s28, s19, 26624
    s_add_u32 m0, s21, 26624
    s_nop 0
    buffer_load_dwordx4 v1, s[4:7], s28 offen lds
    s_add_u32 s28, s19, 27648
    s_add_u32 m0, s21, 27648
    s_nop 0
    buffer_load_dwordx4 v1, s[4:7], s28 offen lds
    s_add_u32 s28, s19, 28672
    s_add_u32 m0, s21, 28672
    s_nop 0
    buffer_load_dwordx4 v1, s[4:7], s28 offen lds
    s_add_u32 s28, s19, 29696
    s_add_u32 m0, s21, 29696
    s_nop 0
    buffer_load_dwordx4 v1, s[4:7], s28 offen lds
    s_add_u32 s28, s19, 30720
    s_add_u32 m0, s21, 30720
    s_nop 0
    buffer_load_dwordx4 v1, s[4:7], s28 offen lds
    s_add_u32 s28, s19, 31744
    s_add_u32 m0, s21, 31744
    s_nop 0
    buffer_load_dwordx4 v1, s[4:7], s28 offen lds
    s_lshl_b32 s3, s23, 15
    v_add_u32 v7, s3, v1
    s_lshl_b32 s3, s22, 15
    s_add_u32 s3, s3, 65536
    v_add_u32 v8, s3, v1
    s_waitcnt vmcnt(32)
    v_sub_f32 v9, 1.0, v6
    v_cvt_pk_bf16_f32 v9, v9, v9
    v_lshlrev_b32 v9, 16, v9
    v_lshlrev_b32 v16, 16, v16
    v_lshlrev_b32 v17, 16, v17
    v_lshlrev_b32 v18, 16, v18
    v_lshlrev_b32 v19, 16, v19
    v_lshlrev_b32 v20, 16, v20
    v_lshlrev_b32 v21, 16, v21
    v_lshlrev_b32 v22, 16, v22
    v_lshlrev_b32 v23, 16, v23
    v_lshlrev_b32 v24, 16, v24
    v_lshlrev_b32 v25, 16, v25
    v_lshlrev_b32 v26, 16, v26
    v_lshlrev_b32 v27, 16, v27
    v_lshlrev_b32 v28, 16, v28
    v_lshlrev_b32 v29, 16, v29
    v_lshlrev_b32 v30, 16, v30
    v_lshlrev_b32 v31, 16, v31
    v_mul_f32 v16, v6, v16
    v_mul_f32 v17, v6, v17
    v_mul_f32 v18, v6, v18
    v_mul_f32 v19, v6, v19
    v_mul_f32 v20, v6, v20
    v_mul_f32 v21, v6, v21
    v_mul_f32 v22, v6, v22
    v_mul_f32 v23, v6, v23
    v_mul_f32 v24, v6, v24
    v_mul_f32 v25, v6, v25
    v_mul_f32 v26, v6, v26
    v_mul_f32 v27, v6, v27
    v_mul_f32 v28, v6, v28
    v_mul_f32 v29, v6, v29
    v_mul_f32 v30, v6, v30
    v_mul_f32 v31, v6, v31
    v_cvt_pk_bf16_f32 v16, v16, v17
    v_cvt_pk_bf16_f32 v17, v18, v19
    v_cvt_pk_bf16_f32 v18, v20, v21
    v_cvt_pk_bf16_f32 v19, v22, v23
    v_cvt_pk_bf16_f32 v20, v24, v25
    v_cvt_pk_bf16_f32 v21, v26, v27
    v_cvt_pk_bf16_f32 v22, v28, v29
    v_cvt_pk_bf16_f32 v23, v30, v31
    v_lshlrev_b32 v112, 16, v16
    v_and_b32 v113, 0xffff0000, v16
    v_lshlrev_b32 v114, 16, v17
    v_and_b32 v115, 0xffff0000, v17
    v_lshlrev_b32 v116, 16, v18
    v_and_b32 v117, 0xffff0000, v18
    v_lshlrev_b32 v118, 16, v19
    v_and_b32 v119, 0xffff0000, v19
    v_lshlrev_b32 v120, 16, v20
    v_and_b32 v121, 0xffff0000, v20
    v_lshlrev_b32 v122, 16, v21
    v_and_b32 v123, 0xffff0000, v21
    v_lshlrev_b32 v124, 16, v22
    v_and_b32 v125, 0xffff0000, v22
    v_lshlrev_b32 v126, 16, v23
    v_and_b32 v127, 0xffff0000, v23
    v_and_b32 v4, 15, v0
    v_mul_u32_u24 v4, 896, v4
    v_bfe_u32 v10, v0, 4, 1
    v_lshl_add_u32 v4, v10, 5, v4
    v_lshl_add_u32 v4, v3, 4, v4
    s_mul_i32 s3, s24, 32*896
    s_lshl_b32 s28, s25, 6
    s_add_u32 s3, s3, s28
    s_add_u32 s29, s3, 16*896
    s_waitcnt vmcnt(24)
    s_barrier
    ds_read_b128 v[48:51], v7 offset:0
    ds_read_b128 v[52:55], v8 offset:0
    ds_read_b128 v[56:59], v7 offset:1024
    ds_read_b128 v[60:63], v8 offset:1024
    s_waitcnt lgkmcnt(2)
    v_mfma_f32_32x32x16_bf16 v[32:47], v[48:51], v[52:55], 0
    ds_read_b128 v[64:67], v7 offset:2048
    ds_read_b128 v[68:71], v8 offset:2048
    s_waitcnt lgkmcnt(2)
    v_mfma_f32_32x32x16_bf16 v[32:47], v[56:59], v[60:63], v[32:47]
    ds_read_b128 v[72:75], v7 offset:3072
    ds_read_b128 v[76:79], v8 offset:3072
    s_waitcnt lgkmcnt(2)
    v_mfma_f32_32x32x16_bf16 v[32:47], v[64:67], v[68:71], v[32:47]
    ds_read_b128 v[80:83], v7 offset:4096
    ds_read_b128 v[84:87], v8 offset:4096
    s_waitcnt lgkmcnt(2)
    v_mfma_f32_32x32x16_bf16 v[32:47], v[72:75], v[76:79], v[32:47]
    ds_read_b128 v[88:91], v7 offset:5120
    ds_read_b128 v[92:95], v8 offset:5120
    s_waitcnt lgkmcnt(2)
    v_mfma_f32_32x32x16_bf16 v[32:47], v[80:83], v[84:87], v[32:47]
    ds_read_b128 v[96:99], v7 offset:6144
    ds_read_b128 v[100:103], v8 offset:6144
    s_waitcnt lgkmcnt(2)
    v_mfma_f32_32x32x16_bf16 v[32:47], v[88:91], v[92:95], v[32:47]
    ds_read_b128 v[104:107], v7 offset:7168
    ds_read_b128 v[108:111], v8 offset:7168
    s_waitcnt lgkmcnt(2)
    v_mfma_f32_32x32x16_bf16 v[32:47], v[96:99], v[100:103], v[32:47]
    s_waitcnt lgkmcnt(0)
    v_mfma_f32_32x32x16_bf16 v[32:47], v[104:107], v[108:111], v[32:47]
    s_waitcnt vmcnt(16)
    s_barrier
    ds_read_b128 v[48:51], v7 offset:8192
    ds_read_b128 v[52:55], v8 offset:8192
    ds_read_b128 v[56:59], v7 offset:9216
    ds_read_b128 v[60:63], v8 offset:9216
    s_waitcnt lgkmcnt(2)
    v_mfma_f32_32x32x16_bf16 v[32:47], v[48:51], v[52:55], v[32:47]
    ds_read_b128 v[64:67], v7 offset:10240
    ds_read_b128 v[68:71], v8 offset:10240
    s_waitcnt lgkmcnt(2)
    v_mfma_f32_32x32x16_bf16 v[32:47], v[56:59], v[60:63], v[32:47]
    ds_read_b128 v[72:75], v7 offset:11264
    ds_read_b128 v[76:79], v8 offset:11264
    s_waitcnt lgkmcnt(2)
    v_mfma_f32_32x32x16_bf16 v[32:47], v[64:67], v[68:71], v[32:47]
    ds_read_b128 v[80:83], v7 offset:12288
    ds_read_b128 v[84:87], v8 offset:12288
    s_waitcnt lgkmcnt(2)
    v_mfma_f32_32x32x16_bf16 v[32:47], v[72:75], v[76:79], v[32:47]
    ds_read_b128 v[88:91], v7 offset:13312
    ds_read_b128 v[92:95], v8 offset:13312
    s_waitcnt lgkmcnt(2)
    v_mfma_f32_32x32x16_bf16 v[32:47], v[80:83], v[84:87], v[32:47]
    ds_read_b128 v[96:99], v7 offset:14336
    ds_read_b128 v[100:103], v8 offset:14336
    s_waitcnt lgkmcnt(2)
    v_mfma_f32_32x32x16_bf16 v[32:47], v[88:91], v[92:95], v[32:47]
    ds_read_b128 v[104:107], v7 offset:15360
    ds_read_b128 v[108:111], v8 offset:15360
    s_waitcnt lgkmcnt(2)
    v_mfma_f32_32x32x16_bf16 v[32:47], v[96:99], v[100:103], v[32:47]
    s_waitcnt lgkmcnt(0)
    v_mfma_f32_32x32x16_bf16 v[32:47], v[104:107], v[108:111], v[32:47]
    s_waitcnt vmcnt(8)
    s_barrier
    ds_read_b128 v[48:51], v7 offset:16384
    ds_read_b128 v[52:55], v8 offset:16384
    ds_read_b128 v[56:59], v7 offset:17408
    ds_read_b128 v[60:63], v8 offset:17408
    s_waitcnt lgkmcnt(2)
    v_mfma_f32_32x32x16_bf16 v[32:47], v[48:51], v[52:55], v[32:47]
    ds_read_b128 v[64:67], v7 offset:18432
    ds_read_b128 v[68:71], v8 offset:18432
    s_waitcnt lgkmcnt(2)
    v_mfma_f32_32x32x16_bf16 v[32:47], v[56:59], v[60:63], v[32:47]
    ds_read_b128 v[72:75], v7 offset:19456
    ds_read_b128 v[76:79], v8 offset:19456
    s_waitcnt lgkmcnt(2)
    v_mfma_f32_32x32x16_bf16 v[32:47], v[64:67], v[68:71], v[32:47]
    ds_read_b128 v[80:83], v7 offset:20480
    ds_read_b128 v[84:87], v8 offset:20480
    s_waitcnt lgkmcnt(2)
    v_mfma_f32_32x32x16_bf16 v[32:47], v[72:75], v[76:79], v[32:47]
    ds_read_b128 v[88:91], v7 offset:21504
    ds_read_b128 v[92:95], v8 offset:21504
    s_waitcnt lgkmcnt(2)
    v_mfma_f32_32x32x16_bf16 v[32:47], v[80:83], v[84:87], v[32:47]
    ds_read_b128 v[96:99], v7 offset:22528
    ds_read_b128 v[100:103], v8 offset:22528
    s_waitcnt lgkmcnt(2)
    v_mfma_f32_32x32x16_bf16 v[32:47], v[88:91], v[92:95], v[32:47]
    ds_read_b128 v[104:107], v7 offset:23552
    ds_read_b128 v[108:111], v8 offset:23552
    s_waitcnt lgkmcnt(2)
    v_mfma_f32_32x32x16_bf16 v[32:47], v[96:99], v[100:103], v[32:47]
    s_waitcnt lgkmcnt(0)
    v_mfma_f32_32x32x16_bf16 v[32:47], v[104:107], v[108:111], v[32:47]
    s_waitcnt vmcnt(0)
    s_barrier
    ds_read_b128 v[48:51], v7 offset:24576
    ds_read_b128 v[52:55], v8 offset:24576
    ds_read_b128 v[56:59], v7 offset:25600
    ds_read_b128 v[60:63], v8 offset:25600
    s_waitcnt lgkmcnt(2)
    v_mfma_f32_32x32x16_bf16 v[32:47], v[48:51], v[52:55], v[32:47]
    ds_read_b128 v[64:67], v7 offset:26624
    ds_read_b128 v[68:71], v8 offset:26624
    s_waitcnt lgkmcnt(2)
    v_mfma_f32_32x32x16_bf16 v[32:47], v[56:59], v[60:63], v[32:47]
    ds_read_b128 v[72:75], v7 offset:27648
    ds_read_b128 v[76:79], v8 offset:27648
    s_waitcnt lgkmcnt(2)
    v_mfma_f32_32x32x16_bf16 v[32:47], v[64:67], v[68:71], v[32:47]
    ds_read_b128 v[80:83], v7 offset:28672
    ds_read_b128 v[84:87], v8 offset:28672
    s_waitcnt lgkmcnt(2)
    v_mfma_f32_32x32x16_bf16 v[32:47], v[72:75], v[76:79], v[32:47]
    ds_read_b128 v[88:91], v7 offset:29696
    ds_read_b128 v[92:95], v8 offset:29696
    s_waitcnt lgkmcnt(2)
    v_mfma_f32_32x32x16_bf16 v[32:47], v[80:83], v[84:87], v[32:47]
    ds_read_b128 v[96:99], v7 offset:30720
    ds_read_b128 v[100:103], v8 offset:30720
    s_waitcnt lgkmcnt(2)
    v_mfma_f32_32x32x16_bf16 v[32:47], v[88:91], v[92:95], v[32:47]
    ds_read_b128 v[104:107], v7 offset:31744
    ds_read_b128 v[108:111], v8 offset:31744
    s_waitcnt lgkmcnt(2)
    v_mfma_f32_32x32x16_bf16 v[32:47], v[96:99], v[100:103], v[32:47]
    s_waitcnt lgkmcnt(0)
    v_mfma_f32_32x32x16_bf16 v[32:47], v[104:107], v[108:111], v[32:47]
    s_nop 7
    s_nop 3
    v_cvt_pk_bf16_f32 v32, v32, v33
    v_cvt_pk_bf16_f32 v33, v34, v35
    v_cvt_pk_bf16_f32 v34, v36, v37
    v_cvt_pk_bf16_f32 v35, v38, v39
    v_cvt_pk_bf16_f32 v36, v40, v41
    v_cvt_pk_bf16_f32 v37, v42, v43
    v_cvt_pk_bf16_f32 v38, v44, v45
    v_cvt_pk_bf16_f32 v39, v46, v47
    v_lshlrev_b32 v48, 16, v32
    v_and_b32 v49, 0xffff0000, v32
    v_lshlrev_b32 v50, 16, v33
    v_and_b32 v51, 0xffff0000, v33
    v_lshlrev_b32 v52, 16, v34
    v_and_b32 v53, 0xffff0000, v34
    v_lshlrev_b32 v54, 16, v35
    v_and_b32 v55, 0xffff0000, v35
    v_lshlrev_b32 v56, 16, v36
    v_and_b32 v57, 0xffff0000, v36
    v_lshlrev_b32 v58, 16, v37
    v_and_b32 v59, 0xffff0000, v37
    v_lshlrev_b32 v60, 16, v38
    v_and_b32 v61, 0xffff0000, v38
    v_lshlrev_b32 v62, 16, v39
    v_and_b32 v63, 0xffff0000, v39
    v_mul_f32 v48, v9, v48
    v_mul_f32 v49, v9, v49
    v_mul_f32 v50, v9, v50
    v_mul_f32 v51, v9, v51
    v_mul_f32 v52, v9, v52
    v_mul_f32 v53, v9, v53
    v_mul_f32 v54, v9, v54
    v_mul_f32 v55, v9, v55
    v_mul_f32 v56, v9, v56
    v_mul_f32 v57, v9, v57
    v_mul_f32 v58, v9, v58
    v_mul_f32 v59, v9, v59
    v_mul_f32 v60, v9, v60
    v_mul_f32 v61, v9, v61
    v_mul_f32 v62, v9, v62
    v_mul_f32 v63, v9, v63
    v_cvt_pk_bf16_f32 v48, v48, v49
    v_cvt_pk_bf16_f32 v49, v50, v51
    v_cvt_pk_bf16_f32 v50, v52, v53
    v_cvt_pk_bf16_f32 v51, v54, v55
    v_cvt_pk_bf16_f32 v52, v56, v57
    v_cvt_pk_bf16_f32 v53, v58, v59
    v_cvt_pk_bf16_f32 v54, v60, v61
    v_cvt_pk_bf16_f32 v55, v62, v63
    v_lshlrev_b32 v66, 16, v48
    v_and_b32 v67, 0xffff0000, v48
    v_add_f32 v64, v112, v66
    v_add_f32 v65, v113, v67
    v_cvt_pk_bf16_f32 v72, v64, v65
    v_lshlrev_b32 v66, 16, v49
    v_and_b32 v67, 0xffff0000, v49
    v_add_f32 v64, v114, v66
    v_add_f32 v65, v115, v67
    v_cvt_pk_bf16_f32 v73, v64, v65
    v_lshlrev_b32 v66, 16, v50
    v_and_b32 v67, 0xffff0000, v50
    v_add_f32 v64, v116, v66
    v_add_f32 v65, v117, v67
    v_cvt_pk_bf16_f32 v74, v64, v65
    v_lshlrev_b32 v66, 16, v51
    v_and_b32 v67, 0xffff0000, v51
    v_add_f32 v64, v118, v66
    v_add_f32 v65, v119, v67
    v_cvt_pk_bf16_f32 v75, v64, v65
    v_lshlrev_b32 v66, 16, v52
    v_and_b32 v67, 0xffff0000, v52
    v_add_f32 v64, v120, v66
    v_add_f32 v65, v121, v67
    v_cvt_pk_bf16_f32 v76, v64, v65
    v_lshlrev_b32 v66, 16, v53
    v_and_b32 v67, 0xffff0000, v53
    v_add_f32 v64, v122, v66
    v_add_f32 v65, v123, v67
    v_cvt_pk_bf16_f32 v77, v64, v65
    v_lshlrev_b32 v66, 16, v54
    v_and_b32 v67, 0xffff0000, v54
    v_add_f32 v64, v124, v66
    v_add_f32 v65, v125, v67
    v_cvt_pk_bf16_f32 v78, v64, v65
    v_lshlrev_b32 v66, 16, v55
    v_and_b32 v67, 0xffff0000, v55
    v_add_f32 v64, v126, v66
    v_add_f32 v65, v127, v67
    v_cvt_pk_bf16_f32 v79, v64, v65
    s_nop 1
    v_permlane32_swap_b32 v72, v74
    v_permlane32_swap_b32 v73, v75
    v_permlane32_swap_b32 v76, v78
    v_permlane32_swap_b32 v77, v79
    s_nop 1
    v_permlane16_swap_b32 v72, v76
    v_permlane16_swap_b32 v73, v77
    v_permlane16_swap_b32 v74, v78
    v_permlane16_swap_b32 v75, v79
    s_nop 1
    buffer_store_dwordx4 v[72:75], v4, s[8:11], s3 offen sc0 sc1
    buffer_store_dwordx4 v[76:79], v4, s[8:11], s29 offen sc0 sc1
    s_endpgm
.section .rodata,"a"
.p2align 6
.amdhsa_kernel gm_ka_kernel
  .amdhsa_next_free_vgpr 192
  .amdhsa_next_free_sgpr 102
  .amdhsa_accum_offset 192
  .amdhsa_group_segment_fixed_size 0
  .amdhsa_kernarg_size 112
  .amdhsa_user_sgpr_count 2
  .amdhsa_user_sgpr_kernarg_segment_ptr 1
  .amdhsa_system_sgpr_workgroup_id_x 1
.end_amdhsa_kernel
.p2align 6
.amdhsa_kernel gm_kb_kernel
  .amdhsa_next_free_vgpr 216
  .amdhsa_next_free_sgpr 102
  .amdhsa_accum_offset 216
  .amdhsa_group_segment_fixed_size 0
  .amdhsa_kernarg_size 112
  .amdhsa_user_sgpr_count 2
  .amdhsa_user_sgpr_kernarg_segment_ptr 1
  .amdhsa_system_sgpr_workgroup_id_x 1
.end_amdhsa_kernel
.p2align 6
.amdhsa_kernel gm_kc_kernel
  .amdhsa_next_free_vgpr 128
  .amdhsa_next_free_sgpr 102
  .amdhsa_accum_offset 128
  .amdhsa_group_segment_fixed_size 0
  .amdhsa_kernarg_size 112
  .amdhsa_user_sgpr_count 2
  .amdhsa_user_sgpr_kernarg_segment_ptr 1
  .amdhsa_system_sgpr_workgroup_id_x 1
.end_amdhsa_kernel
```
